```python
import torch

def _softmax(x, axis=-1):
    return torch.softmax(x, dim=axis)
def _gelu(x):
    return torch.nn.functional.gelu(x, approximate="tanh")
def _silu(x):
    return torch.nn.functional.silu(x)
def _sigmoid(x):
    return torch.sigmoid(x)
def _layernorm(x, axis=-1, eps=1e-5):
    m = x.mean(dim=axis, keepdim=True)
    v = x.var(dim=axis, keepdim=True, unbiased=False)
    return (x - m) / torch.sqrt(v + eps)
def _scatter_add(tgt, idx, src, axis=0):
    return tgt.clone().index_add_(axis, idx, src)
def _segment_sum(src, seg, n):
    out = torch.zeros((n,) + src.shape[1:], dtype=src.dtype)
    return out.index_add_(0, seg, src)
def _pad(x, pw):
    flat = tuple(v for pair in reversed(pw) for v in pair)
    return torch.nn.functional.pad(x, flat)

kernel_name = 'gated_mix__softmax_full_mha__grouped_kv_mqa__prompt'

def setup_inputs():

    _w = (lambda a: (lambda t: t.to(torch.bfloat16) if t.is_floating_point() else t)(torch.as_tensor(a)))
    def _A_setup():
        B, S, D = 1, 2048, 512
        return {
            "x": _w((lambda *s: torch.randn(*s, dtype=torch.bfloat16) * 0.05)(B, S, D)),
            "wqkv": _w((lambda *s: torch.randn(*s, dtype=torch.bfloat16) * 3.2)(D, 3 * D)),
            "wo": _w((lambda *s: torch.randn(*s, dtype=torch.bfloat16) * 1.6)(D, D)),
        }
    _A_in = _A_setup()

    def _B_setup():
        B, S, D, H = 1, 2048, 512, 32
        Dh = D // H
        return {
            "x": _w((lambda *s: torch.randn(*s, dtype=torch.bfloat16) * 0.05)(B, S, D)),
            "wq": _w((lambda *s: torch.randn(*s, dtype=torch.bfloat16) * 3.2)(D, H * Dh)),
            "wk": _w((lambda *s: torch.randn(*s, dtype=torch.bfloat16) * 3.2)(D, Dh)),
            "wv": _w((lambda *s: torch.randn(*s, dtype=torch.bfloat16) * 1.6)(D, Dh)),
            "wo": _w((lambda *s: torch.randn(*s, dtype=torch.bfloat16) * 1.6)(H * Dh, D)),
        }
    _B_in = _B_setup()

    return {
        "A_x": _A_in["x"],
        "A_wqkv": _A_in["wqkv"],
        "A_wo": _A_in["wo"],
        "B_x": _B_in["x"],
        "B_wq": _B_in["wq"],
        "B_wk": _B_in["wk"],
        "B_wv": _B_in["wv"],
        "B_wo": _B_in["wo"],
        "gate_w": _w((lambda *s: torch.randn(*s, dtype=torch.bfloat16) * 0.05)(512) * 16.0),
    }

def reference(A_x, A_wqkv, A_wo, B_x, B_wq, B_wk, B_wv, B_wo, gate_w):
    def _A_ref(x, wqkv, wo):
        B, S, D = x.shape
        H = 32; Dh = D // H
        qkv = (lambda x, *d: x.permute(*d))((x @ wqkv).reshape(B, S, 3, H, Dh), 2, 0, 3, 1, 4)
        q, k, v = qkv[0], qkv[1], qkv[2]
        scale = Dh ** -0.5
        scores = torch.einsum("bhqd,bhkd->bhqk", q, k) * scale
        p = _softmax(scores, axis=-1)
        o = torch.einsum("bhqk,bhkd->bhqd", p, v)
        return (lambda x, *d: x.permute(*d))(o, 0, 2, 1, 3).reshape(B, S, D) @ wo

    def _B_ref(x, wq, wk, wv, wo):
        B, S, D = x.shape
        H = 32
        Dh = D // H
        q = (lambda x, *d: x.permute(*d))((x @ wq).reshape(B, S, H, Dh), 0, 2, 1, 3)
        k = x @ wk
        v = x @ wv
        scores = torch.einsum("bhqd,bkd->bhqk", q, k) * (Dh ** -0.5)
        p = _softmax(scores, axis=-1)
        o = torch.einsum("bhqk,bkd->bhqd", p, v)
        return (lambda x, *d: x.permute(*d))(o, 0, 2, 1, 3).reshape(B, S, H * Dh) @ wo

    x = A_x
    g = _sigmoid((x * gate_w).sum(-1, keepdims=True))
    a = _A_ref(x, A_wqkv, A_wo)
    b = _B_ref(x, B_wq, B_wk, B_wv, B_wo)
    return g * a + (1 - g) * b
```

```asm
; @launch grid=(256,1,1) block=(512,1,1) lds=140288
.amdgcn_target "amdgcn-amd-amdhsa--gfx950"
.text
.globl gated_mix__softmax_full_mha__grouped_kv_mqa__prompt_kernel
.p2align 8
.type gated_mix__softmax_full_mha__grouped_kv_mqa__prompt_kernel,@function
gated_mix__softmax_full_mha__grouped_kv_mqa__prompt_kernel:
    s_cmp_ge_u32 s2, 256
    s_cbranch_scc1 L_exit
    s_load_dwordx4 s[4:7], s[0:1], 0
    s_load_dwordx2 s[40:41], s[0:1], 32
    s_load_dwordx4 s[44:47], s[0:1], 40
    s_load_dwordx2 s[48:49], s[0:1], 64
    s_load_dwordx2 s[50:51], s[0:1], 88
    s_load_dwordx2 s[60:61], s[0:1], 16
    s_load_dwordx2 s[62:63], s[0:1], 56
    s_load_dwordx2 s[64:65], s[0:1], 72
    v_lshrrev_b32 v16, 6, v0
    v_and_b32 v1, 63, v0
    v_readfirstlane_b32 s3, v16
    s_and_b32 s29, s2, 7
    s_lshr_b32 s33, s2, 3
    s_and_b32 s30, s33, 1
    s_lshr_b32 s28, s33, 1
    s_lshr_b32 s32, s28, 1
    s_cmp_eq_u32 s32, s29
    s_cselect_b32 s39, 1, 0
    s_cmp_eq_u32 s30, 0
    s_cselect_b32 s39, s39, 0
    s_getreg_b32 s59, hwreg(HW_REG_XCC_ID, 0, 4)
    s_cmp_lt_u32 s3, 4
    s_cbranch_scc1 PJ_comp
    s_sub_u32 s43, s3, 4
    s_lshr_b32 s32, s43, 1
    s_lshl_b32 s58, s30, 1
    s_add_u32 s58, s58, s32
    s_cmp_eq_u32 s58, 3
    s_mov_b32 s31, 3072
    s_cselect_b32 s31, 1024, s31
    v_lshrrev_b32 v16, 3, v1
    v_lshrrev_b32 v17, 4, v1
    v_and_b32 v18, 7, v1
    v_xor_b32 v19, v18, v17
    v_lshlrev_b32 v19, 4, v19
    v_lshl_add_u32 v2, v16, 10, v19
    v_xor_b32 v3, 64, v2
    v_add_u32 v3, 8192, v3
    v_lshrrev_b32 v16, 5, v1
    v_lshlrev_b32 v16, 2, v16
    v_bfe_u32 v17, v1, 2, 2
    v_add_u32 v16, v16, v17
    v_mul_lo_u32 v16, v16, s31
    v_bfe_u32 v17, v1, 4, 1
    v_lshl_add_u32 v16, v17, 6, v16
    v_and_b32 v17, 3, v1
    v_lshl_add_u32 v4, v17, 4, v16
    v_lshlrev_b32 v5, 4, v1
    s_lshl_b32 s35, s28, 17
    s_lshl_b32 s32, s43, 15
    s_add_u32 s35, s35, s32
    s_and_b32 s32, s43, 1
    s_mul_i32 s36, s32, s31
    s_lshl_b32 s36, s36, 5
    s_lshl_b32 s32, s29, 7
    s_lshl_b32 s33, s58, 10
    s_cmp_eq_u32 s58, 3
    s_cselect_b32 s33, 0, s33
    s_add_u32 s36, s36, s32
    s_add_u32 s36, s36, s33
    s_lshl_b32 s37, s43, 9
    s_cmp_eq_u32 s43, 0
    s_cselect_b32 s42, 0, 0x100000
    s_waitcnt lgkmcnt(0)
    s_mov_b32 s8, s50
    s_and_b32 s9, s51, 0xffff
    s_mov_b32 s10, 0x1000000
    s_mov_b32 s11, 0x00020000
    s_mov_b32 s16, s4
    s_and_b32 s17, s5, 0xffff
    s_mov_b32 s18, 0x200000
    s_mov_b32 s19, 0x00020000
    s_cmp_eq_u32 s58, 3
    s_cselect_b32 s20, s40, s6
    s_cselect_b32 s21, s41, s7
    s_and_b32 s21, s21, 0xffff
    s_lshl_b32 s22, s31, 9
    s_mov_b32 s23, 0x00020000
    s_cmp_eq_u32 s30, 0
    s_cselect_b32 s24, s44, s46
    s_cselect_b32 s25, s45, s47
    s_and_b32 s25, s25, 0xffff
    s_mov_b32 s26, 16384
    s_mov_b32 s27, 0x00020000
    s_mov_b32 s68, s48
    s_and_b32 s69, s49, 0xffff
    s_mov_b32 s70, 0x400
    s_mov_b32 s71, 0x00020000
    s_cmp_eq_u32 s30, 1
    s_cbranch_scc1 PJ_lv
    s_cmp_eq_u32 s39, 1
    s_cbranch_scc1 PJ_lg
    s_lshl_b32 s38, s43, 12
    s_add_u32 s38, s38, 0
    s_mov_b32 s56, s35
    s_mov_b32 m0, s38
    s_add_u32 s38, s38, 1024
    buffer_load_dwordx4 v2, s[16:19], s56 offen lds
    s_mov_b32 m0, s38
    s_add_u32 s38, s38, 1024
    buffer_load_dwordx4 v3, s[16:19], s56 offen lds
    s_mov_b32 m0, s38
    s_add_u32 s38, s38, 1024
    s_add_u32 s56, s56, 16384
    buffer_load_dwordx4 v2, s[16:19], s56 offen lds
    s_mov_b32 m0, s38
    s_add_u32 s38, s38, 13312
    buffer_load_dwordx4 v3, s[16:19], s56 offen lds
    s_add_u32 s35, s35, 128
    s_mov_b32 s57, s36
    s_mov_b32 m0, s38
    s_add_u32 s38, s38, 1024
    buffer_load_dwordx4 v4, s[20:23], s57 offen lds
    s_lshl_b32 s33, s31, 3
    s_add_u32 s57, s57, s33
    s_mov_b32 m0, s38
    s_add_u32 s38, s38, 1024
    buffer_load_dwordx4 v4, s[20:23], s57 offen lds
    s_lshl_b32 s33, s31, 3
    s_add_u32 s57, s57, s33
    s_mov_b32 m0, s38
    s_add_u32 s38, s38, 1024
    buffer_load_dwordx4 v4, s[20:23], s57 offen lds
    s_lshl_b32 s33, s31, 3
    s_add_u32 s57, s57, s33
    s_mov_b32 m0, s38
    s_add_u32 s38, s38, 1024
    buffer_load_dwordx4 v4, s[20:23], s57 offen lds
    s_lshl_b32 s33, s31, 6
    s_add_u32 s36, s36, s33
    s_lshl_b32 s32, s43, 9
    s_add_u32 s32, s32, 32768
    s_mov_b32 m0, s32
    s_mov_b32 exec_hi, 0
    buffer_load_dwordx4 v5, s[24:27], s37 offen lds
    s_add_u32 s37, s37, 2048
    s_mov_b32 exec_hi, -1
    s_lshl_b32 s38, s43, 12
    s_add_u32 s38, s38, 35072
    s_mov_b32 s56, s35
    s_mov_b32 m0, s38
    s_add_u32 s38, s38, 1024
    buffer_load_dwordx4 v2, s[16:19], s56 offen lds
    s_mov_b32 m0, s38
    s_add_u32 s38, s38, 1024
    buffer_load_dwordx4 v3, s[16:19], s56 offen lds
    s_mov_b32 m0, s38
    s_add_u32 s38, s38, 1024
    s_add_u32 s56, s56, 16384
    buffer_load_dwordx4 v2, s[16:19], s56 offen lds
    s_mov_b32 m0, s38
    s_add_u32 s38, s38, 13312
    buffer_load_dwordx4 v3, s[16:19], s56 offen lds
    s_add_u32 s35, s35, 128
    s_mov_b32 s57, s36
    s_mov_b32 m0, s38
    s_add_u32 s38, s38, 1024
    buffer_load_dwordx4 v4, s[20:23], s57 offen lds
    s_lshl_b32 s33, s31, 3
    s_add_u32 s57, s57, s33
    s_mov_b32 m0, s38
    s_add_u32 s38, s38, 1024
    buffer_load_dwordx4 v4, s[20:23], s57 offen lds
    s_lshl_b32 s33, s31, 3
    s_add_u32 s57, s57, s33
    s_mov_b32 m0, s38
    s_add_u32 s38, s38, 1024
    buffer_load_dwordx4 v4, s[20:23], s57 offen lds
    s_lshl_b32 s33, s31, 3
    s_add_u32 s57, s57, s33
    s_mov_b32 m0, s38
    s_add_u32 s38, s38, 1024
    buffer_load_dwordx4 v4, s[20:23], s57 offen lds
    s_lshl_b32 s33, s31, 6
    s_add_u32 s36, s36, s33
    s_lshl_b32 s32, s43, 9
    s_add_u32 s32, s32, 67840
    s_mov_b32 m0, s32
    s_mov_b32 exec_hi, 0
    buffer_load_dwordx4 v5, s[24:27], s37 offen lds
    s_add_u32 s37, s37, 2048
    s_mov_b32 exec_hi, -1
    s_lshl_b32 s38, s43, 12
    s_add_u32 s38, s38, 70144
    s_mov_b32 s56, s35
    s_mov_b32 m0, s38
    s_add_u32 s38, s38, 1024
    buffer_load_dwordx4 v2, s[16:19], s56 offen lds
    s_mov_b32 m0, s38
    s_add_u32 s38, s38, 1024
    buffer_load_dwordx4 v3, s[16:19], s56 offen lds
    s_mov_b32 m0, s38
    s_add_u32 s38, s38, 1024
    s_add_u32 s56, s56, 16384
    buffer_load_dwordx4 v2, s[16:19], s56 offen lds
    s_mov_b32 m0, s38
    s_add_u32 s38, s38, 13312
    buffer_load_dwordx4 v3, s[16:19], s56 offen lds
    s_add_u32 s35, s35, 128
    s_mov_b32 s57, s36
    s_mov_b32 m0, s38
    s_add_u32 s38, s38, 1024
    buffer_load_dwordx4 v4, s[20:23], s57 offen lds
    s_lshl_b32 s33, s31, 3
    s_add_u32 s57, s57, s33
    s_mov_b32 m0, s38
    s_add_u32 s38, s38, 1024
    buffer_load_dwordx4 v4, s[20:23], s57 offen lds
    s_lshl_b32 s33, s31, 3
    s_add_u32 s57, s57, s33
    s_mov_b32 m0, s38
    s_add_u32 s38, s38, 1024
    buffer_load_dwordx4 v4, s[20:23], s57 offen lds
    s_lshl_b32 s33, s31, 3
    s_add_u32 s57, s57, s33
    s_mov_b32 m0, s38
    s_add_u32 s38, s38, 1024
    buffer_load_dwordx4 v4, s[20:23], s57 offen lds
    s_lshl_b32 s33, s31, 6
    s_add_u32 s36, s36, s33
    s_lshl_b32 s32, s43, 9
    s_add_u32 s32, s32, 102912
    s_mov_b32 m0, s32
    s_mov_b32 exec_hi, 0
    buffer_load_dwordx4 v5, s[24:27], s37 offen lds
    s_add_u32 s37, s37, 2048
    s_mov_b32 exec_hi, -1
    v_mov_b32 v16, 13639680
    buffer_load_dword v22, v16, s[8:11], 0 offen sc1
    v_and_b32 v16, 15, v1
    v_lshrrev_b32 v17, 4, v1
    v_bfe_u32 v18, v1, 1, 3
    v_xor_b32 v18, v18, v17
    v_lshlrev_b32 v18, 4, v18
    v_lshl_add_u32 v20, v16, 7, v18
    s_lshl_b32 s32, s43, 12
    v_add_u32 v20, s32, v20
    v_bfe_u32 v16, v1, 2, 2
    v_lshl_add_u32 v16, v17, 3, v16
    v_lshlrev_b32 v16, 5, v16
    v_and_b32 v18, 3, v1
    v_lshl_add_u32 v21, v18, 3, v16
    v_add_u32 v21, 32768, v21
    v_lshlrev_b32 v6, 4, v17
    v_add_u32 v6, 34816, v6
    v_mov_b32 v56, 0
    v_mov_b32 v57, 0
    v_mov_b32 v58, 0
    v_mov_b32 v59, 0
    v_mov_b32 v60, 0
    v_mov_b32 v61, 0
    v_mov_b32 v62, 0
    v_mov_b32 v63, 0
    v_mov_b32 v64, 0
    v_mov_b32 v65, 0
    v_mov_b32 v66, 0
    v_mov_b32 v67, 0
    v_mov_b32 v68, 0
    v_mov_b32 v69, 0
    v_mov_b32 v70, 0
    v_mov_b32 v71, 0
    s_waitcnt vmcnt(19)
    s_barrier
    v_add_u32 v16, 0, v20
    ds_read_b128 v[24:27], v16
    ds_read_b128 v[28:31], v16 offset:2048
    v_add_u32 v17, 0, v21
    ds_read_b64_tr_b16 v[40:41], v17
    ds_read_b64_tr_b16 v[42:43], v17 offset:128
    v_add_u32 v16, 0, v20
    v_xor_b32 v16, 64, v16
    ds_read_b128 v[32:35], v16
    ds_read_b128 v[36:39], v16 offset:2048
    v_add_u32 v17, 1024, v21
    ds_read_b64_tr_b16 v[44:45], v17
    ds_read_b64_tr_b16 v[46:47], v17 offset:128
    s_lshl_b32 s38, s43, 12
    s_add_u32 s38, s38, 105216
    s_mov_b32 s56, s35
    s_mov_b32 m0, s38
    s_add_u32 s38, s38, 1024
    buffer_load_dwordx4 v2, s[16:19], s56 offen lds
    s_mov_b32 m0, s38
    s_add_u32 s38, s38, 1024
    buffer_load_dwordx4 v3, s[16:19], s56 offen lds
    s_mov_b32 m0, s38
    s_add_u32 s38, s38, 1024
    s_add_u32 s56, s56, 16384
    buffer_load_dwordx4 v2, s[16:19], s56 offen lds
    s_mov_b32 m0, s38
    s_add_u32 s38, s38, 13312
    buffer_load_dwordx4 v3, s[16:19], s56 offen lds
    s_add_u32 s35, s35, 128
    s_mov_b32 s57, s36
    s_mov_b32 m0, s38
    s_add_u32 s38, s38, 1024
    buffer_load_dwordx4 v4, s[20:23], s57 offen lds
    s_lshl_b32 s33, s31, 3
    s_add_u32 s57, s57, s33
    s_mov_b32 m0, s38
    s_add_u32 s38, s38, 1024
    buffer_load_dwordx4 v4, s[20:23], s57 offen lds
    s_lshl_b32 s33, s31, 3
    s_add_u32 s57, s57, s33
    s_mov_b32 m0, s38
    s_add_u32 s38, s38, 1024
    buffer_load_dwordx4 v4, s[20:23], s57 offen lds
    s_lshl_b32 s33, s31, 3
    s_add_u32 s57, s57, s33
    s_mov_b32 m0, s38
    s_add_u32 s38, s38, 1024
    buffer_load_dwordx4 v4, s[20:23], s57 offen lds
    s_lshl_b32 s33, s31, 6
    s_add_u32 s36, s36, s33
    s_lshl_b32 s32, s43, 9
    s_add_u32 s32, s32, 137984
    s_mov_b32 m0, s32
    s_mov_b32 exec_hi, 0
    buffer_load_dwordx4 v5, s[24:27], s37 offen lds
    s_add_u32 s37, s37, 2048
    s_mov_b32 exec_hi, -1
    s_waitcnt lgkmcnt(0)
    v_mfma_f32_16x16x32_bf16 v[56:59], v[40:43], v[24:27], v[56:59]
    v_mfma_f32_16x16x32_bf16 v[60:63], v[40:43], v[28:31], v[60:63]
    v_mfma_f32_16x16x32_bf16 v[56:59], v[44:47], v[32:35], v[56:59]
    v_mfma_f32_16x16x32_bf16 v[60:63], v[44:47], v[36:39], v[60:63]
    s_waitcnt vmcnt(18)
    s_barrier
    v_add_u32 v16, 35072, v20
    ds_read_b128 v[24:27], v16
    ds_read_b128 v[28:31], v16 offset:2048
    v_add_u32 v17, 35072, v21
    ds_read_b64_tr_b16 v[40:41], v17
    ds_read_b64_tr_b16 v[42:43], v17 offset:128
    v_add_u32 v16, 35072, v20
    v_xor_b32 v16, 64, v16
    ds_read_b128 v[32:35], v16
    ds_read_b128 v[36:39], v16 offset:2048
    v_add_u32 v17, 36096, v21
    ds_read_b64_tr_b16 v[44:45], v17
    ds_read_b64_tr_b16 v[46:47], v17 offset:128
    s_lshl_b32 s38, s43, 12
    s_add_u32 s38, s38, 0
    s_mov_b32 s56, s35
    s_mov_b32 m0, s38
    s_add_u32 s38, s38, 1024
    buffer_load_dwordx4 v2, s[16:19], s56 offen lds
    s_mov_b32 m0, s38
    s_add_u32 s38, s38, 1024
    buffer_load_dwordx4 v3, s[16:19], s56 offen lds
    s_mov_b32 m0, s38
    s_add_u32 s38, s38, 1024
    s_add_u32 s56, s56, 16384
    buffer_load_dwordx4 v2, s[16:19], s56 offen lds
    s_mov_b32 m0, s38
    s_add_u32 s38, s38, 13312
    buffer_load_dwordx4 v3, s[16:19], s56 offen lds
    s_add_u32 s35, s35, 128
    s_mov_b32 s57, s36
    s_mov_b32 m0, s38
    s_add_u32 s38, s38, 1024
    buffer_load_dwordx4 v4, s[20:23], s57 offen lds
    s_lshl_b32 s33, s31, 3
    s_add_u32 s57, s57, s33
    s_mov_b32 m0, s38
    s_add_u32 s38, s38, 1024
    buffer_load_dwordx4 v4, s[20:23], s57 offen lds
    s_lshl_b32 s33, s31, 3
    s_add_u32 s57, s57, s33
    s_mov_b32 m0, s38
    s_add_u32 s38, s38, 1024
    buffer_load_dwordx4 v4, s[20:23], s57 offen lds
    s_lshl_b32 s33, s31, 3
    s_add_u32 s57, s57, s33
    s_mov_b32 m0, s38
    s_add_u32 s38, s38, 1024
    buffer_load_dwordx4 v4, s[20:23], s57 offen lds
    s_lshl_b32 s33, s31, 6
    s_add_u32 s36, s36, s33
    s_lshl_b32 s32, s43, 9
    s_add_u32 s32, s32, 32768
    s_mov_b32 m0, s32
    s_mov_b32 exec_hi, 0
    buffer_load_dwordx4 v5, s[24:27], s37 offen lds
    s_add_u32 s37, s37, 2048
    s_mov_b32 exec_hi, -1
    s_waitcnt lgkmcnt(0)
    v_mfma_f32_16x16x32_bf16 v[56:59], v[40:43], v[24:27], v[56:59]
    v_mfma_f32_16x16x32_bf16 v[60:63], v[40:43], v[28:31], v[60:63]
    v_mfma_f32_16x16x32_bf16 v[56:59], v[44:47], v[32:35], v[56:59]
    v_mfma_f32_16x16x32_bf16 v[60:63], v[44:47], v[36:39], v[60:63]
    s_waitcnt vmcnt(18)
    s_barrier
    v_add_u32 v16, 70144, v20
    ds_read_b128 v[24:27], v16
    ds_read_b128 v[28:31], v16 offset:2048
    v_add_u32 v17, 70144, v21
    ds_read_b64_tr_b16 v[40:41], v17
    ds_read_b64_tr_b16 v[42:43], v17 offset:128
    v_add_u32 v16, 70144, v20
    v_xor_b32 v16, 64, v16
    ds_read_b128 v[32:35], v16
    ds_read_b128 v[36:39], v16 offset:2048
    v_add_u32 v17, 71168, v21
    ds_read_b64_tr_b16 v[44:45], v17
    ds_read_b64_tr_b16 v[46:47], v17 offset:128
    s_lshl_b32 s38, s43, 12
    s_add_u32 s38, s38, 35072
    s_mov_b32 s56, s35
    s_mov_b32 m0, s38
    s_add_u32 s38, s38, 1024
    buffer_load_dwordx4 v2, s[16:19], s56 offen lds
    s_mov_b32 m0, s38
    s_add_u32 s38, s38, 1024
    buffer_load_dwordx4 v3, s[16:19], s56 offen lds
    s_mov_b32 m0, s38
    s_add_u32 s38, s38, 1024
    s_add_u32 s56, s56, 16384
    buffer_load_dwordx4 v2, s[16:19], s56 offen lds
    s_mov_b32 m0, s38
    s_add_u32 s38, s38, 13312
    buffer_load_dwordx4 v3, s[16:19], s56 offen lds
    s_add_u32 s35, s35, 128
    s_mov_b32 s57, s36
    s_mov_b32 m0, s38
    s_add_u32 s38, s38, 1024
    buffer_load_dwordx4 v4, s[20:23], s57 offen lds
    s_lshl_b32 s33, s31, 3
    s_add_u32 s57, s57, s33
    s_mov_b32 m0, s38
    s_add_u32 s38, s38, 1024
    buffer_load_dwordx4 v4, s[20:23], s57 offen lds
    s_lshl_b32 s33, s31, 3
    s_add_u32 s57, s57, s33
    s_mov_b32 m0, s38
    s_add_u32 s38, s38, 1024
    buffer_load_dwordx4 v4, s[20:23], s57 offen lds
    s_lshl_b32 s33, s31, 3
    s_add_u32 s57, s57, s33
    s_mov_b32 m0, s38
    s_add_u32 s38, s38, 1024
    buffer_load_dwordx4 v4, s[20:23], s57 offen lds
    s_lshl_b32 s33, s31, 6
    s_add_u32 s36, s36, s33
    s_lshl_b32 s32, s43, 9
    s_add_u32 s32, s32, 67840
    s_mov_b32 m0, s32
    s_mov_b32 exec_hi, 0
    buffer_load_dwordx4 v5, s[24:27], s37 offen lds
    s_add_u32 s37, s37, 2048
    s_mov_b32 exec_hi, -1
    v_readfirstlane_b32 s12, v22
    s_nop 1
    s_add_u32 s59, s59, 1
    s_add_u32 s12, s12, 0x9e3779b9
    s_add_u32 s59, s59, s12
    s_waitcnt lgkmcnt(0)
    v_mfma_f32_16x16x32_bf16 v[56:59], v[40:43], v[24:27], v[56:59]
    v_mfma_f32_16x16x32_bf16 v[60:63], v[40:43], v[28:31], v[60:63]
    v_mfma_f32_16x16x32_bf16 v[56:59], v[44:47], v[32:35], v[56:59]
    v_mfma_f32_16x16x32_bf16 v[60:63], v[44:47], v[36:39], v[60:63]
    s_waitcnt vmcnt(18)
    s_barrier
    v_add_u32 v16, 105216, v20
    ds_read_b128 v[24:27], v16
    ds_read_b128 v[28:31], v16 offset:2048
    v_add_u32 v17, 105216, v21
    ds_read_b64_tr_b16 v[40:41], v17
    ds_read_b64_tr_b16 v[42:43], v17 offset:128
    v_add_u32 v16, 105216, v20
    v_xor_b32 v16, 64, v16
    ds_read_b128 v[32:35], v16
    ds_read_b128 v[36:39], v16 offset:2048
    v_add_u32 v17, 106240, v21
    ds_read_b64_tr_b16 v[44:45], v17
    ds_read_b64_tr_b16 v[46:47], v17 offset:128
    s_lshl_b32 s38, s43, 12
    s_add_u32 s38, s38, 70144
    s_mov_b32 s56, s35
    s_mov_b32 m0, s38
    s_add_u32 s38, s38, 1024
    buffer_load_dwordx4 v2, s[16:19], s56 offen lds
    s_mov_b32 m0, s38
    s_add_u32 s38, s38, 1024
    buffer_load_dwordx4 v3, s[16:19], s56 offen lds
    s_mov_b32 m0, s38
    s_add_u32 s38, s38, 1024
    s_add_u32 s56, s56, 16384
    buffer_load_dwordx4 v2, s[16:19], s56 offen lds
    s_mov_b32 m0, s38
    s_add_u32 s38, s38, 13312
    buffer_load_dwordx4 v3, s[16:19], s56 offen lds
    s_add_u32 s35, s35, 128
    s_mov_b32 s57, s36
    s_mov_b32 m0, s38
    s_add_u32 s38, s38, 1024
    buffer_load_dwordx4 v4, s[20:23], s57 offen lds
    s_lshl_b32 s33, s31, 3
    s_add_u32 s57, s57, s33
    s_mov_b32 m0, s38
    s_add_u32 s38, s38, 1024
    buffer_load_dwordx4 v4, s[20:23], s57 offen lds
    s_lshl_b32 s33, s31, 3
    s_add_u32 s57, s57, s33
    s_mov_b32 m0, s38
    s_add_u32 s38, s38, 1024
    buffer_load_dwordx4 v4, s[20:23], s57 offen lds
    s_lshl_b32 s33, s31, 3
    s_add_u32 s57, s57, s33
    s_mov_b32 m0, s38
    s_add_u32 s38, s38, 1024
    buffer_load_dwordx4 v4, s[20:23], s57 offen lds
    s_lshl_b32 s33, s31, 6
    s_add_u32 s36, s36, s33
    s_lshl_b32 s32, s43, 9
    s_add_u32 s32, s32, 102912
    s_mov_b32 m0, s32
    s_mov_b32 exec_hi, 0
    buffer_load_dwordx4 v5, s[24:27], s37 offen lds
    s_add_u32 s37, s37, 2048
    s_mov_b32 exec_hi, -1
    s_waitcnt lgkmcnt(0)
    v_mfma_f32_16x16x32_bf16 v[56:59], v[40:43], v[24:27], v[56:59]
    v_mfma_f32_16x16x32_bf16 v[60:63], v[40:43], v[28:31], v[60:63]
    v_mfma_f32_16x16x32_bf16 v[56:59], v[44:47], v[32:35], v[56:59]
    v_mfma_f32_16x16x32_bf16 v[60:63], v[44:47], v[36:39], v[60:63]
    s_waitcnt vmcnt(18)
    s_barrier
    v_add_u32 v16, 0, v20
    ds_read_b128 v[24:27], v16
    ds_read_b128 v[28:31], v16 offset:2048
    v_add_u32 v17, 0, v21
    ds_read_b64_tr_b16 v[40:41], v17
    ds_read_b64_tr_b16 v[42:43], v17 offset:128
    v_add_u32 v16, 0, v20
    v_xor_b32 v16, 64, v16
    ds_read_b128 v[32:35], v16
    ds_read_b128 v[36:39], v16 offset:2048
    v_add_u32 v17, 1024, v21
    ds_read_b64_tr_b16 v[44:45], v17
    ds_read_b64_tr_b16 v[46:47], v17 offset:128
    s_lshl_b32 s38, s43, 12
    s_add_u32 s38, s38, 105216
    s_mov_b32 s56, s35
    s_mov_b32 m0, s38
    s_add_u32 s38, s38, 1024
    buffer_load_dwordx4 v2, s[16:19], s56 offen lds
    s_mov_b32 m0, s38
    s_add_u32 s38, s38, 1024
    buffer_load_dwordx4 v3, s[16:19], s56 offen lds
    s_mov_b32 m0, s38
    s_add_u32 s38, s38, 1024
    s_add_u32 s56, s56, 16384
    buffer_load_dwordx4 v2, s[16:19], s56 offen lds
    s_mov_b32 m0, s38
    s_add_u32 s38, s38, 13312
    buffer_load_dwordx4 v3, s[16:19], s56 offen lds
    s_add_u32 s35, s35, 128
    s_mov_b32 s57, s36
    s_mov_b32 m0, s38
    s_add_u32 s38, s38, 1024
    buffer_load_dwordx4 v4, s[20:23], s57 offen lds
    s_lshl_b32 s33, s31, 3
    s_add_u32 s57, s57, s33
    s_mov_b32 m0, s38
    s_add_u32 s38, s38, 1024
    buffer_load_dwordx4 v4, s[20:23], s57 offen lds
    s_lshl_b32 s33, s31, 3
    s_add_u32 s57, s57, s33
    s_mov_b32 m0, s38
    s_add_u32 s38, s38, 1024
    buffer_load_dwordx4 v4, s[20:23], s57 offen lds
    s_lshl_b32 s33, s31, 3
    s_add_u32 s57, s57, s33
    s_mov_b32 m0, s38
    s_add_u32 s38, s38, 1024
    buffer_load_dwordx4 v4, s[20:23], s57 offen lds
    s_lshl_b32 s33, s31, 6
    s_add_u32 s36, s36, s33
    s_lshl_b32 s32, s43, 9
    s_add_u32 s32, s32, 137984
    s_mov_b32 m0, s32
    s_mov_b32 exec_hi, 0
    buffer_load_dwordx4 v5, s[24:27], s37 offen lds
    s_add_u32 s37, s37, 2048
    s_mov_b32 exec_hi, -1
    s_waitcnt lgkmcnt(0)
    v_mfma_f32_16x16x32_bf16 v[56:59], v[40:43], v[24:27], v[56:59]
    v_mfma_f32_16x16x32_bf16 v[60:63], v[40:43], v[28:31], v[60:63]
    v_mfma_f32_16x16x32_bf16 v[56:59], v[44:47], v[32:35], v[56:59]
    v_mfma_f32_16x16x32_bf16 v[60:63], v[44:47], v[36:39], v[60:63]
    s_waitcnt vmcnt(18)
    s_barrier
    v_add_u32 v16, 35072, v20
    ds_read_b128 v[24:27], v16
    ds_read_b128 v[28:31], v16 offset:2048
    v_add_u32 v17, 35072, v21
    ds_read_b64_tr_b16 v[40:41], v17
    ds_read_b64_tr_b16 v[42:43], v17 offset:128
    v_add_u32 v16, 35072, v20
    v_xor_b32 v16, 64, v16
    ds_read_b128 v[32:35], v16
    ds_read_b128 v[36:39], v16 offset:2048
    v_add_u32 v17, 36096, v21
    ds_read_b64_tr_b16 v[44:45], v17
    ds_read_b64_tr_b16 v[46:47], v17 offset:128
    v_and_b32 v16, 31, v1
    v_lshlrev_b32 v16, 2, v16
    s_lshl_b32 s32, s29, 7
    s_add_u32 s32, s32, 13647872
    buffer_load_dword v128, v16, s[8:11], s32 offen sc1
    s_waitcnt lgkmcnt(0)
    v_mfma_f32_16x16x32_bf16 v[56:59], v[40:43], v[24:27], v[56:59]
    v_mfma_f32_16x16x32_bf16 v[60:63], v[40:43], v[28:31], v[60:63]
    v_mfma_f32_16x16x32_bf16 v[56:59], v[44:47], v[32:35], v[56:59]
    v_mfma_f32_16x16x32_bf16 v[60:63], v[44:47], v[36:39], v[60:63]
    s_waitcnt vmcnt(10)
    s_barrier
    v_add_u32 v16, 70144, v20
    ds_read_b128 v[24:27], v16
    ds_read_b128 v[28:31], v16 offset:2048
    v_add_u32 v17, 70144, v21
    ds_read_b64_tr_b16 v[40:41], v17
    ds_read_b64_tr_b16 v[42:43], v17 offset:128
    v_add_u32 v16, 70144, v20
    v_xor_b32 v16, 64, v16
    ds_read_b128 v[32:35], v16
    ds_read_b128 v[36:39], v16 offset:2048
    v_add_u32 v17, 71168, v21
    ds_read_b64_tr_b16 v[44:45], v17
    ds_read_b64_tr_b16 v[46:47], v17 offset:128
    s_waitcnt lgkmcnt(0)
    v_mfma_f32_16x16x32_bf16 v[56:59], v[40:43], v[24:27], v[56:59]
    v_mfma_f32_16x16x32_bf16 v[60:63], v[40:43], v[28:31], v[60:63]
    v_mfma_f32_16x16x32_bf16 v[56:59], v[44:47], v[32:35], v[56:59]
    v_mfma_f32_16x16x32_bf16 v[60:63], v[44:47], v[36:39], v[60:63]
    s_waitcnt vmcnt(1)
    s_barrier
    v_add_u32 v16, 105216, v20
    ds_read_b128 v[24:27], v16
    ds_read_b128 v[28:31], v16 offset:2048
    v_add_u32 v17, 105216, v21
    ds_read_b64_tr_b16 v[40:41], v17
    ds_read_b64_tr_b16 v[42:43], v17 offset:128
    v_add_u32 v16, 105216, v20
    v_xor_b32 v16, 64, v16
    ds_read_b128 v[32:35], v16
    ds_read_b128 v[36:39], v16 offset:2048
    v_add_u32 v17, 106240, v21
    ds_read_b64_tr_b16 v[44:45], v17
    ds_read_b64_tr_b16 v[46:47], v17 offset:128
    s_waitcnt lgkmcnt(0)
    v_mfma_f32_16x16x32_bf16 v[56:59], v[40:43], v[24:27], v[56:59]
    v_mfma_f32_16x16x32_bf16 v[60:63], v[40:43], v[28:31], v[60:63]
    v_mfma_f32_16x16x32_bf16 v[56:59], v[44:47], v[32:35], v[56:59]
    v_mfma_f32_16x16x32_bf16 v[60:63], v[44:47], v[36:39], v[60:63]
    s_waitcnt vmcnt(0)
    v_cmp_eq_u32 s[66:67], s59, v128
    s_lshl_b32 s32, s28, 2
    s_add_u32 s32, s32, s43
    v_and_b32 v16, 15, v1
    v_lshrrev_b32 v17, 4, v1
    v_and_b32 v18, 1, v17
    v_lshrrev_b32 v19, 1, v17
    s_add_u32 s33, s29, 32
    s_lshl_b32 s33, s33, 16
    s_lshl_b32 s34, s32, 10
    s_add_u32 s33, s33, s34
    v_and_b32 v21, 3, v16
    v_bfe_u32 v20, v16, 2, 1
    v_lshl_or_b32 v21, v20, 3, v21
    v_bfe_u32 v20, v16, 3, 1
    v_lshl_or_b32 v21, v20, 2, v21
    v_lshlrev_b32 v21, 4, v21
    v_lshl_add_u32 v21, v18, 9, v21
    v_lshl_add_u32 v21, v19, 3, v21
    s_add_u32 s33, s33, 4194304
    s_nop 3
    v_cvt_pk_bf16_f32 v24, v56, v57
    v_cvt_pk_bf16_f32 v25, v58, v59
    v_cvt_pk_bf16_f32 v32, v60, v61
    v_cvt_pk_bf16_f32 v33, v62, v63
    s_cmp_eq_u64 s[66:67], -1
    s_cbranch_scc1 PJ_md1_fast
    buffer_store_dwordx2 v[24:25], v21, s[8:11], s33 offen offset:0 sc1
    buffer_store_dwordx2 v[32:33], v21, s[8:11], s33 offen offset:256 sc1
    s_branch PJ_md1_done
PJ_md1_fast:
    buffer_store_dwordx2 v[24:25], v21, s[8:11], s33 offen offset:0
    buffer_store_dwordx2 v[32:33], v21, s[8:11], s33 offen offset:256
PJ_md1_done:
    s_branch PJ_end
PJ_lg:
    s_lshl_b32 s38, s43, 12
    s_add_u32 s38, s38, 0
    s_mov_b32 s56, s35
    s_mov_b32 m0, s38
    s_add_u32 s38, s38, 1024
    buffer_load_dwordx4 v2, s[16:19], s56 offen lds
    s_mov_b32 m0, s38
    s_add_u32 s38, s38, 1024
    buffer_load_dwordx4 v3, s[16:19], s56 offen lds
    s_mov_b32 m0, s38
    s_add_u32 s38, s38, 1024
    s_add_u32 s56, s56, 16384
    buffer_load_dwordx4 v2, s[16:19], s56 offen lds
    s_mov_b32 m0, s38
    s_add_u32 s38, s38, 13312
    buffer_load_dwordx4 v3, s[16:19], s56 offen lds
    s_add_u32 s35, s35, 128
    s_mov_b32 s57, s36
    s_mov_b32 m0, s38
    s_add_u32 s38, s38, 1024
    buffer_load_dwordx4 v4, s[20:23], s57 offen lds
    s_lshl_b32 s33, s31, 3
    s_add_u32 s57, s57, s33
    s_mov_b32 m0, s38
    s_add_u32 s38, s38, 1024
    buffer_load_dwordx4 v4, s[20:23], s57 offen lds
    s_lshl_b32 s33, s31, 3
    s_add_u32 s57, s57, s33
    s_mov_b32 m0, s38
    s_add_u32 s38, s38, 1024
    buffer_load_dwordx4 v4, s[20:23], s57 offen lds
    s_lshl_b32 s33, s31, 3
    s_add_u32 s57, s57, s33
    s_mov_b32 m0, s38
    s_add_u32 s38, s38, 1024
    buffer_load_dwordx4 v4, s[20:23], s57 offen lds
    s_lshl_b32 s33, s31, 6
    s_add_u32 s36, s36, s33
    s_lshl_b32 s32, s43, 9
    s_add_u32 s32, s32, 32768
    s_mov_b32 m0, s32
    s_mov_b32 exec_hi, 0
    buffer_load_dwordx4 v5, s[24:27], s37 offen lds
    s_add_u32 s37, s37, 2048
    s_cmp_eq_u32 s43, 0
    s_cselect_b32 s32, 0, 128
    s_add_u32 s32, s32, 34816
    s_mov_b32 m0, s32
    s_mov_b32 exec_lo, 0xff
    buffer_load_dwordx4 v5, s[68:71], s42 offen lds
    s_mov_b32 exec_lo, -1
    s_add_u32 s42, s42, 128
    s_mov_b32 exec_hi, -1
    s_lshl_b32 s38, s43, 12
    s_add_u32 s38, s38, 35072
    s_mov_b32 s56, s35
    s_mov_b32 m0, s38
    s_add_u32 s38, s38, 1024
    buffer_load_dwordx4 v2, s[16:19], s56 offen lds
    s_mov_b32 m0, s38
    s_add_u32 s38, s38, 1024
    buffer_load_dwordx4 v3, s[16:19], s56 offen lds
    s_mov_b32 m0, s38
    s_add_u32 s38, s38, 1024
    s_add_u32 s56, s56, 16384
    buffer_load_dwordx4 v2, s[16:19], s56 offen lds
    s_mov_b32 m0, s38
    s_add_u32 s38, s38, 13312
    buffer_load_dwordx4 v3, s[16:19], s56 offen lds
    s_add_u32 s35, s35, 128
    s_mov_b32 s57, s36
    s_mov_b32 m0, s38
    s_add_u32 s38, s38, 1024
    buffer_load_dwordx4 v4, s[20:23], s57 offen lds
    s_lshl_b32 s33, s31, 3
    s_add_u32 s57, s57, s33
    s_mov_b32 m0, s38
    s_add_u32 s38, s38, 1024
    buffer_load_dwordx4 v4, s[20:23], s57 offen lds
    s_lshl_b32 s33, s31, 3
    s_add_u32 s57, s57, s33
    s_mov_b32 m0, s38
    s_add_u32 s38, s38, 1024
    buffer_load_dwordx4 v4, s[20:23], s57 offen lds
    s_lshl_b32 s33, s31, 3
    s_add_u32 s57, s57, s33
    s_mov_b32 m0, s38
    s_add_u32 s38, s38, 1024
    buffer_load_dwordx4 v4, s[20:23], s57 offen lds
    s_lshl_b32 s33, s31, 6
    s_add_u32 s36, s36, s33
    s_lshl_b32 s32, s43, 9
    s_add_u32 s32, s32, 67840
    s_mov_b32 m0, s32
    s_mov_b32 exec_hi, 0
    buffer_load_dwordx4 v5, s[24:27], s37 offen lds
    s_add_u32 s37, s37, 2048
    s_cmp_eq_u32 s43, 0
    s_cselect_b32 s32, 0, 128
    s_add_u32 s32, s32, 69888
    s_mov_b32 m0, s32
    s_mov_b32 exec_lo, 0xff
    buffer_load_dwordx4 v5, s[68:71], s42 offen lds
    s_mov_b32 exec_lo, -1
    s_add_u32 s42, s42, 128
    s_mov_b32 exec_hi, -1
    s_lshl_b32 s38, s43, 12
    s_add_u32 s38, s38, 70144
    s_mov_b32 s56, s35
    s_mov_b32 m0, s38
    s_add_u32 s38, s38, 1024
    buffer_load_dwordx4 v2, s[16:19], s56 offen lds
    s_mov_b32 m0, s38
    s_add_u32 s38, s38, 1024
    buffer_load_dwordx4 v3, s[16:19], s56 offen lds
    s_mov_b32 m0, s38
    s_add_u32 s38, s38, 1024
    s_add_u32 s56, s56, 16384
    buffer_load_dwordx4 v2, s[16:19], s56 offen lds
    s_mov_b32 m0, s38
    s_add_u32 s38, s38, 13312
    buffer_load_dwordx4 v3, s[16:19], s56 offen lds
    s_add_u32 s35, s35, 128
    s_mov_b32 s57, s36
    s_mov_b32 m0, s38
    s_add_u32 s38, s38, 1024
    buffer_load_dwordx4 v4, s[20:23], s57 offen lds
    s_lshl_b32 s33, s31, 3
    s_add_u32 s57, s57, s33
    s_mov_b32 m0, s38
    s_add_u32 s38, s38, 1024
    buffer_load_dwordx4 v4, s[20:23], s57 offen lds
    s_lshl_b32 s33, s31, 3
    s_add_u32 s57, s57, s33
    s_mov_b32 m0, s38
    s_add_u32 s38, s38, 1024
    buffer_load_dwordx4 v4, s[20:23], s57 offen lds
    s_lshl_b32 s33, s31, 3
    s_add_u32 s57, s57, s33
    s_mov_b32 m0, s38
    s_add_u32 s38, s38, 1024
    buffer_load_dwordx4 v4, s[20:23], s57 offen lds
    s_lshl_b32 s33, s31, 6
    s_add_u32 s36, s36, s33
    s_lshl_b32 s32, s43, 9
    s_add_u32 s32, s32, 102912
    s_mov_b32 m0, s32
    s_mov_b32 exec_hi, 0
    buffer_load_dwordx4 v5, s[24:27], s37 offen lds
    s_add_u32 s37, s37, 2048
    s_cmp_eq_u32 s43, 0
    s_cselect_b32 s32, 0, 128
    s_add_u32 s32, s32, 104960
    s_mov_b32 m0, s32
    s_mov_b32 exec_lo, 0xff
    buffer_load_dwordx4 v5, s[68:71], s42 offen lds
    s_mov_b32 exec_lo, -1
    s_add_u32 s42, s42, 128
    s_mov_b32 exec_hi, -1
    v_mov_b32 v16, 13639680
    buffer_load_dword v22, v16, s[8:11], 0 offen sc1
    v_and_b32 v16, 15, v1
    v_lshrrev_b32 v17, 4, v1
    v_bfe_u32 v18, v1, 1, 3
    v_xor_b32 v18, v18, v17
    v_lshlrev_b32 v18, 4, v18
    v_lshl_add_u32 v20, v16, 7, v18
    s_lshl_b32 s32, s43, 12
    v_add_u32 v20, s32, v20
    v_bfe_u32 v16, v1, 2, 2
    v_lshl_add_u32 v16, v17, 3, v16
    v_lshlrev_b32 v16, 5, v16
    v_and_b32 v18, 3, v1
    v_lshl_add_u32 v21, v18, 3, v16
    v_add_u32 v21, 32768, v21
    v_lshlrev_b32 v6, 4, v17
    v_add_u32 v6, 34816, v6
    v_mov_b32 v56, 0
    v_mov_b32 v57, 0
    v_mov_b32 v58, 0
    v_mov_b32 v59, 0
    v_mov_b32 v60, 0
    v_mov_b32 v61, 0
    v_mov_b32 v62, 0
    v_mov_b32 v63, 0
    v_mov_b32 v64, 0
    v_mov_b32 v65, 0
    v_mov_b32 v66, 0
    v_mov_b32 v67, 0
    v_mov_b32 v68, 0
    v_mov_b32 v69, 0
    v_mov_b32 v70, 0
    v_mov_b32 v71, 0
    s_waitcnt vmcnt(21)
    s_barrier
    v_add_u32 v16, 0, v20
    ds_read_b128 v[24:27], v16
    ds_read_b128 v[28:31], v16 offset:2048
    v_add_u32 v17, 0, v21
    ds_read_b64_tr_b16 v[40:41], v17
    ds_read_b64_tr_b16 v[42:43], v17 offset:128
    v_add_u32 v18, 0, v6
    ds_read_b128 v[48:51], v18
    v_add_u32 v16, 0, v20
    v_xor_b32 v16, 64, v16
    ds_read_b128 v[32:35], v16
    ds_read_b128 v[36:39], v16 offset:2048
    v_add_u32 v17, 1024, v21
    ds_read_b64_tr_b16 v[44:45], v17
    ds_read_b64_tr_b16 v[46:47], v17 offset:128
    v_add_u32 v18, 64, v6
    ds_read_b128 v[52:55], v18
    s_lshl_b32 s38, s43, 12
    s_add_u32 s38, s38, 105216
    s_mov_b32 s56, s35
    s_mov_b32 m0, s38
    s_add_u32 s38, s38, 1024
    buffer_load_dwordx4 v2, s[16:19], s56 offen lds
    s_mov_b32 m0, s38
    s_add_u32 s38, s38, 1024
    buffer_load_dwordx4 v3, s[16:19], s56 offen lds
    s_mov_b32 m0, s38
    s_add_u32 s38, s38, 1024
    s_add_u32 s56, s56, 16384
    buffer_load_dwordx4 v2, s[16:19], s56 offen lds
    s_mov_b32 m0, s38
    s_add_u32 s38, s38, 13312
    buffer_load_dwordx4 v3, s[16:19], s56 offen lds
    s_add_u32 s35, s35, 128
    s_mov_b32 s57, s36
    s_mov_b32 m0, s38
    s_add_u32 s38, s38, 1024
    buffer_load_dwordx4 v4, s[20:23], s57 offen lds
    s_lshl_b32 s33, s31, 3
    s_add_u32 s57, s57, s33
    s_mov_b32 m0, s38
    s_add_u32 s38, s38, 1024
    buffer_load_dwordx4 v4, s[20:23], s57 offen lds
    s_lshl_b32 s33, s31, 3
    s_add_u32 s57, s57, s33
    s_mov_b32 m0, s38
    s_add_u32 s38, s38, 1024
    buffer_load_dwordx4 v4, s[20:23], s57 offen lds
    s_lshl_b32 s33, s31, 3
    s_add_u32 s57, s57, s33
    s_mov_b32 m0, s38
    s_add_u32 s38, s38, 1024
    buffer_load_dwordx4 v4, s[20:23], s57 offen lds
    s_lshl_b32 s33, s31, 6
    s_add_u32 s36, s36, s33
    s_lshl_b32 s32, s43, 9
    s_add_u32 s32, s32, 137984
    s_mov_b32 m0, s32
    s_mov_b32 exec_hi, 0
    buffer_load_dwordx4 v5, s[24:27], s37 offen lds
    s_add_u32 s37, s37, 2048
    s_cmp_eq_u32 s43, 0
    s_cselect_b32 s32, 0, 128
    s_add_u32 s32, s32, 140032
    s_mov_b32 m0, s32
    s_mov_b32 exec_lo, 0xff
    buffer_load_dwordx4 v5, s[68:71], s42 offen lds
    s_mov_b32 exec_lo, -1
    s_add_u32 s42, s42, 128
    s_mov_b32 exec_hi, -1
    s_waitcnt lgkmcnt(0)
    v_mfma_f32_16x16x32_bf16 v[56:59], v[40:43], v[24:27], v[56:59]
    v_mfma_f32_16x16x32_bf16 v[64:67], v[48:51], v[24:27], v[64:67]
    v_mfma_f32_16x16x32_bf16 v[60:63], v[40:43], v[28:31], v[60:63]
    v_mfma_f32_16x16x32_bf16 v[68:71], v[48:51], v[28:31], v[68:71]
    v_mfma_f32_16x16x32_bf16 v[56:59], v[44:47], v[32:35], v[56:59]
    v_mfma_f32_16x16x32_bf16 v[64:67], v[52:55], v[32:35], v[64:67]
    v_mfma_f32_16x16x32_bf16 v[60:63], v[44:47], v[36:39], v[60:63]
    v_mfma_f32_16x16x32_bf16 v[68:71], v[52:55], v[36:39], v[68:71]
    s_waitcnt vmcnt(20)
    s_barrier
    v_add_u32 v16, 35072, v20
    ds_read_b128 v[24:27], v16
    ds_read_b128 v[28:31], v16 offset:2048
    v_add_u32 v17, 35072, v21
    ds_read_b64_tr_b16 v[40:41], v17
    ds_read_b64_tr_b16 v[42:43], v17 offset:128
    v_add_u32 v18, 35072, v6
    ds_read_b128 v[48:51], v18
    v_add_u32 v16, 35072, v20
    v_xor_b32 v16, 64, v16
    ds_read_b128 v[32:35], v16
    ds_read_b128 v[36:39], v16 offset:2048
    v_add_u32 v17, 36096, v21
    ds_read_b64_tr_b16 v[44:45], v17
    ds_read_b64_tr_b16 v[46:47], v17 offset:128
    v_add_u32 v18, 35136, v6
    ds_read_b128 v[52:55], v18
    s_lshl_b32 s38, s43, 12
    s_add_u32 s38, s38, 0
    s_mov_b32 s56, s35
    s_mov_b32 m0, s38
    s_add_u32 s38, s38, 1024
    buffer_load_dwordx4 v2, s[16:19], s56 offen lds
    s_mov_b32 m0, s38
    s_add_u32 s38, s38, 1024
    buffer_load_dwordx4 v3, s[16:19], s56 offen lds
    s_mov_b32 m0, s38
    s_add_u32 s38, s38, 1024
    s_add_u32 s56, s56, 16384
    buffer_load_dwordx4 v2, s[16:19], s56 offen lds
    s_mov_b32 m0, s38
    s_add_u32 s38, s38, 13312
    buffer_load_dwordx4 v3, s[16:19], s56 offen lds
    s_add_u32 s35, s35, 128
    s_mov_b32 s57, s36
    s_mov_b32 m0, s38
    s_add_u32 s38, s38, 1024
    buffer_load_dwordx4 v4, s[20:23], s57 offen lds
    s_lshl_b32 s33, s31, 3
    s_add_u32 s57, s57, s33
    s_mov_b32 m0, s38
    s_add_u32 s38, s38, 1024
    buffer_load_dwordx4 v4, s[20:23], s57 offen lds
    s_lshl_b32 s33, s31, 3
    s_add_u32 s57, s57, s33
    s_mov_b32 m0, s38
    s_add_u32 s38, s38, 1024
    buffer_load_dwordx4 v4, s[20:23], s57 offen lds
    s_lshl_b32 s33, s31, 3
    s_add_u32 s57, s57, s33
    s_mov_b32 m0, s38
    s_add_u32 s38, s38, 1024
    buffer_load_dwordx4 v4, s[20:23], s57 offen lds
    s_lshl_b32 s33, s31, 6
    s_add_u32 s36, s36, s33
    s_lshl_b32 s32, s43, 9
    s_add_u32 s32, s32, 32768
    s_mov_b32 m0, s32
    s_mov_b32 exec_hi, 0
    buffer_load_dwordx4 v5, s[24:27], s37 offen lds
    s_add_u32 s37, s37, 2048
    s_cmp_eq_u32 s43, 0
    s_cselect_b32 s32, 0, 128
    s_add_u32 s32, s32, 34816
    s_mov_b32 m0, s32
    s_mov_b32 exec_lo, 0xff
    buffer_load_dwordx4 v5, s[68:71], s42 offen lds
    s_mov_b32 exec_lo, -1
    s_add_u32 s42, s42, 128
    s_mov_b32 exec_hi, -1
    s_waitcnt lgkmcnt(0)
    v_mfma_f32_16x16x32_bf16 v[56:59], v[40:43], v[24:27], v[56:59]
    v_mfma_f32_16x16x32_bf16 v[64:67], v[48:51], v[24:27], v[64:67]
    v_mfma_f32_16x16x32_bf16 v[60:63], v[40:43], v[28:31], v[60:63]
    v_mfma_f32_16x16x32_bf16 v[68:71], v[48:51], v[28:31], v[68:71]
    v_mfma_f32_16x16x32_bf16 v[56:59], v[44:47], v[32:35], v[56:59]
    v_mfma_f32_16x16x32_bf16 v[64:67], v[52:55], v[32:35], v[64:67]
    v_mfma_f32_16x16x32_bf16 v[60:63], v[44:47], v[36:39], v[60:63]
    v_mfma_f32_16x16x32_bf16 v[68:71], v[52:55], v[36:39], v[68:71]
    s_waitcnt vmcnt(20)
    s_barrier
    v_add_u32 v16, 70144, v20
    ds_read_b128 v[24:27], v16
    ds_read_b128 v[28:31], v16 offset:2048
    v_add_u32 v17, 70144, v21
    ds_read_b64_tr_b16 v[40:41], v17
    ds_read_b64_tr_b16 v[42:43], v17 offset:128
    v_add_u32 v18, 70144, v6
    ds_read_b128 v[48:51], v18
    v_add_u32 v16, 70144, v20
    v_xor_b32 v16, 64, v16
    ds_read_b128 v[32:35], v16
    ds_read_b128 v[36:39], v16 offset:2048
    v_add_u32 v17, 71168, v21
    ds_read_b64_tr_b16 v[44:45], v17
    ds_read_b64_tr_b16 v[46:47], v17 offset:128
    v_add_u32 v18, 70208, v6
    ds_read_b128 v[52:55], v18
    s_lshl_b32 s38, s43, 12
    s_add_u32 s38, s38, 35072
    s_mov_b32 s56, s35
    s_mov_b32 m0, s38
    s_add_u32 s38, s38, 1024
    buffer_load_dwordx4 v2, s[16:19], s56 offen lds
    s_mov_b32 m0, s38
    s_add_u32 s38, s38, 1024
    buffer_load_dwordx4 v3, s[16:19], s56 offen lds
    s_mov_b32 m0, s38
    s_add_u32 s38, s38, 1024
    s_add_u32 s56, s56, 16384
    buffer_load_dwordx4 v2, s[16:19], s56 offen lds
    s_mov_b32 m0, s38
    s_add_u32 s38, s38, 13312
    buffer_load_dwordx4 v3, s[16:19], s56 offen lds
    s_add_u32 s35, s35, 128
    s_mov_b32 s57, s36
    s_mov_b32 m0, s38
    s_add_u32 s38, s38, 1024
    buffer_load_dwordx4 v4, s[20:23], s57 offen lds
    s_lshl_b32 s33, s31, 3
    s_add_u32 s57, s57, s33
    s_mov_b32 m0, s38
    s_add_u32 s38, s38, 1024
    buffer_load_dwordx4 v4, s[20:23], s57 offen lds
    s_lshl_b32 s33, s31, 3
    s_add_u32 s57, s57, s33
    s_mov_b32 m0, s38
    s_add_u32 s38, s38, 1024
    buffer_load_dwordx4 v4, s[20:23], s57 offen lds
    s_lshl_b32 s33, s31, 3
    s_add_u32 s57, s57, s33
    s_mov_b32 m0, s38
    s_add_u32 s38, s38, 1024
    buffer_load_dwordx4 v4, s[20:23], s57 offen lds
    s_lshl_b32 s33, s31, 6
    s_add_u32 s36, s36, s33
    s_lshl_b32 s32, s43, 9
    s_add_u32 s32, s32, 67840
    s_mov_b32 m0, s32
    s_mov_b32 exec_hi, 0
    buffer_load_dwordx4 v5, s[24:27], s37 offen lds
    s_add_u32 s37, s37, 2048
    s_cmp_eq_u32 s43, 0
    s_cselect_b32 s32, 0, 128
    s_add_u32 s32, s32, 69888
    s_mov_b32 m0, s32
    s_mov_b32 exec_lo, 0xff
    buffer_load_dwordx4 v5, s[68:71], s42 offen lds
    s_mov_b32 exec_lo, -1
    s_add_u32 s42, s42, 128
    s_mov_b32 exec_hi, -1
    v_readfirstlane_b32 s12, v22
    s_nop 1
    s_add_u32 s59, s59, 1
    s_add_u32 s12, s12, 0x9e3779b9
    s_add_u32 s59, s59, s12
    s_waitcnt lgkmcnt(0)
    v_mfma_f32_16x16x32_bf16 v[56:59], v[40:43], v[24:27], v[56:59]
    v_mfma_f32_16x16x32_bf16 v[64:67], v[48:51], v[24:27], v[64:67]
    v_mfma_f32_16x16x32_bf16 v[60:63], v[40:43], v[28:31], v[60:63]
    v_mfma_f32_16x16x32_bf16 v[68:71], v[48:51], v[28:31], v[68:71]
    v_mfma_f32_16x16x32_bf16 v[56:59], v[44:47], v[32:35], v[56:59]
    v_mfma_f32_16x16x32_bf16 v[64:67], v[52:55], v[32:35], v[64:67]
    v_mfma_f32_16x16x32_bf16 v[60:63], v[44:47], v[36:39], v[60:63]
    v_mfma_f32_16x16x32_bf16 v[68:71], v[52:55], v[36:39], v[68:71]
    s_waitcnt vmcnt(20)
    s_barrier
    v_add_u32 v16, 105216, v20
    ds_read_b128 v[24:27], v16
    ds_read_b128 v[28:31], v16 offset:2048
    v_add_u32 v17, 105216, v21
    ds_read_b64_tr_b16 v[40:41], v17
    ds_read_b64_tr_b16 v[42:43], v17 offset:128
    v_add_u32 v18, 105216, v6
    ds_read_b128 v[48:51], v18
    v_add_u32 v16, 105216, v20
    v_xor_b32 v16, 64, v16
    ds_read_b128 v[32:35], v16
    ds_read_b128 v[36:39], v16 offset:2048
    v_add_u32 v17, 106240, v21
    ds_read_b64_tr_b16 v[44:45], v17
    ds_read_b64_tr_b16 v[46:47], v17 offset:128
    v_add_u32 v18, 105280, v6
    ds_read_b128 v[52:55], v18
    s_lshl_b32 s38, s43, 12
    s_add_u32 s38, s38, 70144
    s_mov_b32 s56, s35
    s_mov_b32 m0, s38
    s_add_u32 s38, s38, 1024
    buffer_load_dwordx4 v2, s[16:19], s56 offen lds
    s_mov_b32 m0, s38
    s_add_u32 s38, s38, 1024
    buffer_load_dwordx4 v3, s[16:19], s56 offen lds
    s_mov_b32 m0, s38
    s_add_u32 s38, s38, 1024
    s_add_u32 s56, s56, 16384
    buffer_load_dwordx4 v2, s[16:19], s56 offen lds
    s_mov_b32 m0, s38
    s_add_u32 s38, s38, 13312
    buffer_load_dwordx4 v3, s[16:19], s56 offen lds
    s_add_u32 s35, s35, 128
    s_mov_b32 s57, s36
    s_mov_b32 m0, s38
    s_add_u32 s38, s38, 1024
    buffer_load_dwordx4 v4, s[20:23], s57 offen lds
    s_lshl_b32 s33, s31, 3
    s_add_u32 s57, s57, s33
    s_mov_b32 m0, s38
    s_add_u32 s38, s38, 1024
    buffer_load_dwordx4 v4, s[20:23], s57 offen lds
    s_lshl_b32 s33, s31, 3
    s_add_u32 s57, s57, s33
    s_mov_b32 m0, s38
    s_add_u32 s38, s38, 1024
    buffer_load_dwordx4 v4, s[20:23], s57 offen lds
    s_lshl_b32 s33, s31, 3
    s_add_u32 s57, s57, s33
    s_mov_b32 m0, s38
    s_add_u32 s38, s38, 1024
    buffer_load_dwordx4 v4, s[20:23], s57 offen lds
    s_lshl_b32 s33, s31, 6
    s_add_u32 s36, s36, s33
    s_lshl_b32 s32, s43, 9
    s_add_u32 s32, s32, 102912
    s_mov_b32 m0, s32
    s_mov_b32 exec_hi, 0
    buffer_load_dwordx4 v5, s[24:27], s37 offen lds
    s_add_u32 s37, s37, 2048
    s_cmp_eq_u32 s43, 0
    s_cselect_b32 s32, 0, 128
    s_add_u32 s32, s32, 104960
    s_mov_b32 m0, s32
    s_mov_b32 exec_lo, 0xff
    buffer_load_dwordx4 v5, s[68:71], s42 offen lds
    s_mov_b32 exec_lo, -1
    s_add_u32 s42, s42, 128
    s_mov_b32 exec_hi, -1
    s_waitcnt lgkmcnt(0)
    v_mfma_f32_16x16x32_bf16 v[56:59], v[40:43], v[24:27], v[56:59]
    v_mfma_f32_16x16x32_bf16 v[64:67], v[48:51], v[24:27], v[64:67]
    v_mfma_f32_16x16x32_bf16 v[60:63], v[40:43], v[28:31], v[60:63]
    v_mfma_f32_16x16x32_bf16 v[68:71], v[48:51], v[28:31], v[68:71]
    v_mfma_f32_16x16x32_bf16 v[56:59], v[44:47], v[32:35], v[56:59]
    v_mfma_f32_16x16x32_bf16 v[64:67], v[52:55], v[32:35], v[64:67]
    v_mfma_f32_16x16x32_bf16 v[60:63], v[44:47], v[36:39], v[60:63]
    v_mfma_f32_16x16x32_bf16 v[68:71], v[52:55], v[36:39], v[68:71]
    s_waitcnt vmcnt(20)
    s_barrier
    v_add_u32 v16, 0, v20
    ds_read_b128 v[24:27], v16
    ds_read_b128 v[28:31], v16 offset:2048
    v_add_u32 v17, 0, v21
    ds_read_b64_tr_b16 v[40:41], v17
    ds_read_b64_tr_b16 v[42:43], v17 offset:128
    v_add_u32 v18, 0, v6
    ds_read_b128 v[48:51], v18
    v_add_u32 v16, 0, v20
    v_xor_b32 v16, 64, v16
    ds_read_b128 v[32:35], v16
    ds_read_b128 v[36:39], v16 offset:2048
    v_add_u32 v17, 1024, v21
    ds_read_b64_tr_b16 v[44:45], v17
    ds_read_b64_tr_b16 v[46:47], v17 offset:128
    v_add_u32 v18, 64, v6
    ds_read_b128 v[52:55], v18
    s_lshl_b32 s38, s43, 12
    s_add_u32 s38, s38, 105216
    s_mov_b32 s56, s35
    s_mov_b32 m0, s38
    s_add_u32 s38, s38, 1024
    buffer_load_dwordx4 v2, s[16:19], s56 offen lds
    s_mov_b32 m0, s38
    s_add_u32 s38, s38, 1024
    buffer_load_dwordx4 v3, s[16:19], s56 offen lds
    s_mov_b32 m0, s38
    s_add_u32 s38, s38, 1024
    s_add_u32 s56, s56, 16384
    buffer_load_dwordx4 v2, s[16:19], s56 offen lds
    s_mov_b32 m0, s38
    s_add_u32 s38, s38, 13312
    buffer_load_dwordx4 v3, s[16:19], s56 offen lds
    s_add_u32 s35, s35, 128
    s_mov_b32 s57, s36
    s_mov_b32 m0, s38
    s_add_u32 s38, s38, 1024
    buffer_load_dwordx4 v4, s[20:23], s57 offen lds
    s_lshl_b32 s33, s31, 3
    s_add_u32 s57, s57, s33
    s_mov_b32 m0, s38
    s_add_u32 s38, s38, 1024
    buffer_load_dwordx4 v4, s[20:23], s57 offen lds
    s_lshl_b32 s33, s31, 3
    s_add_u32 s57, s57, s33
    s_mov_b32 m0, s38
    s_add_u32 s38, s38, 1024
    buffer_load_dwordx4 v4, s[20:23], s57 offen lds
    s_lshl_b32 s33, s31, 3
    s_add_u32 s57, s57, s33
    s_mov_b32 m0, s38
    s_add_u32 s38, s38, 1024
    buffer_load_dwordx4 v4, s[20:23], s57 offen lds
    s_lshl_b32 s33, s31, 6
    s_add_u32 s36, s36, s33
    s_lshl_b32 s32, s43, 9
    s_add_u32 s32, s32, 137984
    s_mov_b32 m0, s32
    s_mov_b32 exec_hi, 0
    buffer_load_dwordx4 v5, s[24:27], s37 offen lds
    s_add_u32 s37, s37, 2048
    s_cmp_eq_u32 s43, 0
    s_cselect_b32 s32, 0, 128
    s_add_u32 s32, s32, 140032
    s_mov_b32 m0, s32
    s_mov_b32 exec_lo, 0xff
    buffer_load_dwordx4 v5, s[68:71], s42 offen lds
    s_mov_b32 exec_lo, -1
    s_add_u32 s42, s42, 128
    s_mov_b32 exec_hi, -1
    s_waitcnt lgkmcnt(0)
    v_mfma_f32_16x16x32_bf16 v[56:59], v[40:43], v[24:27], v[56:59]
    v_mfma_f32_16x16x32_bf16 v[64:67], v[48:51], v[24:27], v[64:67]
    v_mfma_f32_16x16x32_bf16 v[60:63], v[40:43], v[28:31], v[60:63]
    v_mfma_f32_16x16x32_bf16 v[68:71], v[48:51], v[28:31], v[68:71]
    v_mfma_f32_16x16x32_bf16 v[56:59], v[44:47], v[32:35], v[56:59]
    v_mfma_f32_16x16x32_bf16 v[64:67], v[52:55], v[32:35], v[64:67]
    v_mfma_f32_16x16x32_bf16 v[60:63], v[44:47], v[36:39], v[60:63]
    v_mfma_f32_16x16x32_bf16 v[68:71], v[52:55], v[36:39], v[68:71]
    s_waitcnt vmcnt(20)
    s_barrier
    v_add_u32 v16, 35072, v20
    ds_read_b128 v[24:27], v16
    ds_read_b128 v[28:31], v16 offset:2048
    v_add_u32 v17, 35072, v21
    ds_read_b64_tr_b16 v[40:41], v17
    ds_read_b64_tr_b16 v[42:43], v17 offset:128
    v_add_u32 v18, 35072, v6
    ds_read_b128 v[48:51], v18
    v_add_u32 v16, 35072, v20
    v_xor_b32 v16, 64, v16
    ds_read_b128 v[32:35], v16
    ds_read_b128 v[36:39], v16 offset:2048
    v_add_u32 v17, 36096, v21
    ds_read_b64_tr_b16 v[44:45], v17
    ds_read_b64_tr_b16 v[46:47], v17 offset:128
    v_add_u32 v18, 35136, v6
    ds_read_b128 v[52:55], v18
    v_and_b32 v16, 31, v1
    v_lshlrev_b32 v16, 2, v16
    s_lshl_b32 s32, s29, 7
    s_add_u32 s32, s32, 13647872
    buffer_load_dword v128, v16, s[8:11], s32 offen sc1
    s_waitcnt lgkmcnt(0)
    v_mfma_f32_16x16x32_bf16 v[56:59], v[40:43], v[24:27], v[56:59]
    v_mfma_f32_16x16x32_bf16 v[64:67], v[48:51], v[24:27], v[64:67]
    v_mfma_f32_16x16x32_bf16 v[60:63], v[40:43], v[28:31], v[60:63]
    v_mfma_f32_16x16x32_bf16 v[68:71], v[48:51], v[28:31], v[68:71]
    v_mfma_f32_16x16x32_bf16 v[56:59], v[44:47], v[32:35], v[56:59]
    v_mfma_f32_16x16x32_bf16 v[64:67], v[52:55], v[32:35], v[64:67]
    v_mfma_f32_16x16x32_bf16 v[60:63], v[44:47], v[36:39], v[60:63]
    v_mfma_f32_16x16x32_bf16 v[68:71], v[52:55], v[36:39], v[68:71]
    s_waitcnt vmcnt(11)
    s_barrier
    v_add_u32 v16, 70144, v20
    ds_read_b128 v[24:27], v16
    ds_read_b128 v[28:31], v16 offset:2048
    v_add_u32 v17, 70144, v21
    ds_read_b64_tr_b16 v[40:41], v17
    ds_read_b64_tr_b16 v[42:43], v17 offset:128
    v_add_u32 v18, 70144, v6
    ds_read_b128 v[48:51], v18
    v_add_u32 v16, 70144, v20
    v_xor_b32 v16, 64, v16
    ds_read_b128 v[32:35], v16
    ds_read_b128 v[36:39], v16 offset:2048
    v_add_u32 v17, 71168, v21
    ds_read_b64_tr_b16 v[44:45], v17
    ds_read_b64_tr_b16 v[46:47], v17 offset:128
    v_add_u32 v18, 70208, v6
    ds_read_b128 v[52:55], v18
    s_waitcnt lgkmcnt(0)
    v_mfma_f32_16x16x32_bf16 v[56:59], v[40:43], v[24:27], v[56:59]
    v_mfma_f32_16x16x32_bf16 v[64:67], v[48:51], v[24:27], v[64:67]
    v_mfma_f32_16x16x32_bf16 v[60:63], v[40:43], v[28:31], v[60:63]
    v_mfma_f32_16x16x32_bf16 v[68:71], v[48:51], v[28:31], v[68:71]
    v_mfma_f32_16x16x32_bf16 v[56:59], v[44:47], v[32:35], v[56:59]
    v_mfma_f32_16x16x32_bf16 v[64:67], v[52:55], v[32:35], v[64:67]
    v_mfma_f32_16x16x32_bf16 v[60:63], v[44:47], v[36:39], v[60:63]
    v_mfma_f32_16x16x32_bf16 v[68:71], v[52:55], v[36:39], v[68:71]
    s_waitcnt vmcnt(1)
    s_barrier
    v_add_u32 v16, 105216, v20
    ds_read_b128 v[24:27], v16
    ds_read_b128 v[28:31], v16 offset:2048
    v_add_u32 v17, 105216, v21
    ds_read_b64_tr_b16 v[40:41], v17
    ds_read_b64_tr_b16 v[42:43], v17 offset:128
    v_add_u32 v18, 105216, v6
    ds_read_b128 v[48:51], v18
    v_add_u32 v16, 105216, v20
    v_xor_b32 v16, 64, v16
    ds_read_b128 v[32:35], v16
    ds_read_b128 v[36:39], v16 offset:2048
    v_add_u32 v17, 106240, v21
    ds_read_b64_tr_b16 v[44:45], v17
    ds_read_b64_tr_b16 v[46:47], v17 offset:128
    v_add_u32 v18, 105280, v6
    ds_read_b128 v[52:55], v18
    s_waitcnt lgkmcnt(0)
    v_mfma_f32_16x16x32_bf16 v[56:59], v[40:43], v[24:27], v[56:59]
    v_mfma_f32_16x16x32_bf16 v[64:67], v[48:51], v[24:27], v[64:67]
    v_mfma_f32_16x16x32_bf16 v[60:63], v[40:43], v[28:31], v[60:63]
    v_mfma_f32_16x16x32_bf16 v[68:71], v[48:51], v[28:31], v[68:71]
    v_mfma_f32_16x16x32_bf16 v[56:59], v[44:47], v[32:35], v[56:59]
    v_mfma_f32_16x16x32_bf16 v[64:67], v[52:55], v[32:35], v[64:67]
    v_mfma_f32_16x16x32_bf16 v[60:63], v[44:47], v[36:39], v[60:63]
    v_mfma_f32_16x16x32_bf16 v[68:71], v[52:55], v[36:39], v[68:71]
    s_waitcnt vmcnt(0)
    v_cmp_eq_u32 s[66:67], s59, v128
    s_lshl_b32 s32, s28, 2
    s_add_u32 s32, s32, s43
    v_and_b32 v16, 15, v1
    v_lshrrev_b32 v17, 4, v1
    v_and_b32 v18, 1, v17
    v_lshrrev_b32 v19, 1, v17
    s_add_u32 s33, s29, 32
    s_lshl_b32 s33, s33, 16
    s_lshl_b32 s34, s32, 10
    s_add_u32 s33, s33, s34
    v_and_b32 v21, 3, v16
    v_bfe_u32 v20, v16, 2, 1
    v_lshl_or_b32 v21, v20, 3, v21
    v_bfe_u32 v20, v16, 3, 1
    v_lshl_or_b32 v21, v20, 2, v21
    v_lshlrev_b32 v21, 4, v21
    v_lshl_add_u32 v21, v18, 9, v21
    v_lshl_add_u32 v21, v19, 3, v21
    s_add_u32 s33, s33, 4194304
    s_nop 3
    v_cvt_pk_bf16_f32 v24, v56, v57
    v_cvt_pk_bf16_f32 v25, v58, v59
    v_cvt_pk_bf16_f32 v32, v60, v61
    v_cvt_pk_bf16_f32 v33, v62, v63
    s_lshl_b32 s34, s32, 7
    s_add_u32 s34, s34, 13664256
    v_lshlrev_b32 v16, 2, v16
    v_cmp_eq_u32 vcc, 0, v17
    v_mul_f32 v64, 0xbfb8aa3b, v64
    v_exp_f32 v64, v64
    s_nop 0
    v_add_f32 v64, 1.0, v64
    v_rcp_f32 v64, v64
    v_mul_f32 v68, 0xbfb8aa3b, v68
    v_exp_f32 v68, v68
    s_nop 0
    v_add_f32 v68, 1.0, v68
    v_rcp_f32 v68, v68
    s_nop 0
    s_cmp_eq_u64 s[66:67], -1
    s_cbranch_scc1 PJ_md2_fast
    buffer_store_dwordx2 v[24:25], v21, s[8:11], s33 offen offset:0 sc1
    buffer_store_dwordx2 v[32:33], v21, s[8:11], s33 offen offset:256 sc1
    s_and_saveexec_b64 s[52:53], vcc
    buffer_store_dword v64, v16, s[8:11], s34 offen offset:0 sc1
    buffer_store_dword v68, v16, s[8:11], s34 offen offset:64 sc1
    s_mov_b64 exec, s[52:53]
    s_branch PJ_md2_done
PJ_md2_fast:
    buffer_store_dwordx2 v[24:25], v21, s[8:11], s33 offen offset:0
    buffer_store_dwordx2 v[32:33], v21, s[8:11], s33 offen offset:256
    s_and_saveexec_b64 s[52:53], vcc
    buffer_store_dword v64, v16, s[8:11], s34 offen offset:0
    buffer_store_dword v68, v16, s[8:11], s34 offen offset:64
    s_mov_b64 exec, s[52:53]
PJ_md2_done:
    s_branch PJ_end
PJ_lv:
    s_lshl_b32 s38, s43, 12
    s_add_u32 s38, s38, 0
    s_mov_b32 s56, s35
    s_mov_b32 m0, s38
    s_add_u32 s38, s38, 1024
    buffer_load_dwordx4 v2, s[16:19], s56 offen lds
    s_mov_b32 m0, s38
    s_add_u32 s38, s38, 1024
    buffer_load_dwordx4 v3, s[16:19], s56 offen lds
    s_mov_b32 m0, s38
    s_add_u32 s38, s38, 1024
    s_add_u32 s56, s56, 16384
    buffer_load_dwordx4 v2, s[16:19], s56 offen lds
    s_mov_b32 m0, s38
    s_add_u32 s38, s38, 13312
    buffer_load_dwordx4 v3, s[16:19], s56 offen lds
    s_add_u32 s35, s35, 128
    s_mov_b32 s57, s36
    s_mov_b32 m0, s38
    s_add_u32 s38, s38, 1024
    buffer_load_dwordx4 v4, s[20:23], s57 offen lds
    s_lshl_b32 s33, s31, 3
    s_add_u32 s57, s57, s33
    s_mov_b32 m0, s38
    s_add_u32 s38, s38, 1024
    buffer_load_dwordx4 v4, s[20:23], s57 offen lds
    s_lshl_b32 s33, s31, 3
    s_add_u32 s57, s57, s33
    s_mov_b32 m0, s38
    s_add_u32 s38, s38, 1024
    buffer_load_dwordx4 v4, s[20:23], s57 offen lds
    s_lshl_b32 s33, s31, 3
    s_add_u32 s57, s57, s33
    s_mov_b32 m0, s38
    s_add_u32 s38, s38, 1024
    buffer_load_dwordx4 v4, s[20:23], s57 offen lds
    s_lshl_b32 s33, s31, 6
    s_add_u32 s36, s36, s33
    s_lshl_b32 s32, s43, 9
    s_add_u32 s32, s32, 32768
    s_mov_b32 m0, s32
    s_mov_b32 exec_hi, 0
    buffer_load_dwordx4 v5, s[24:27], s37 offen lds
    s_add_u32 s37, s37, 2048
    s_mov_b32 exec_hi, -1
    s_lshl_b32 s38, s43, 12
    s_add_u32 s38, s38, 35072
    s_mov_b32 s56, s35
    s_mov_b32 m0, s38
    s_add_u32 s38, s38, 1024
    buffer_load_dwordx4 v2, s[16:19], s56 offen lds
    s_mov_b32 m0, s38
    s_add_u32 s38, s38, 1024
    buffer_load_dwordx4 v3, s[16:19], s56 offen lds
    s_mov_b32 m0, s38
    s_add_u32 s38, s38, 1024
    s_add_u32 s56, s56, 16384
    buffer_load_dwordx4 v2, s[16:19], s56 offen lds
    s_mov_b32 m0, s38
    s_add_u32 s38, s38, 13312
    buffer_load_dwordx4 v3, s[16:19], s56 offen lds
    s_add_u32 s35, s35, 128
    s_mov_b32 s57, s36
    s_mov_b32 m0, s38
    s_add_u32 s38, s38, 1024
    buffer_load_dwordx4 v4, s[20:23], s57 offen lds
    s_lshl_b32 s33, s31, 3
    s_add_u32 s57, s57, s33
    s_mov_b32 m0, s38
    s_add_u32 s38, s38, 1024
    buffer_load_dwordx4 v4, s[20:23], s57 offen lds
    s_lshl_b32 s33, s31, 3
    s_add_u32 s57, s57, s33
    s_mov_b32 m0, s38
    s_add_u32 s38, s38, 1024
    buffer_load_dwordx4 v4, s[20:23], s57 offen lds
    s_lshl_b32 s33, s31, 3
    s_add_u32 s57, s57, s33
    s_mov_b32 m0, s38
    s_add_u32 s38, s38, 1024
    buffer_load_dwordx4 v4, s[20:23], s57 offen lds
    s_lshl_b32 s33, s31, 6
    s_add_u32 s36, s36, s33
    s_lshl_b32 s32, s43, 9
    s_add_u32 s32, s32, 67840
    s_mov_b32 m0, s32
    s_mov_b32 exec_hi, 0
    buffer_load_dwordx4 v5, s[24:27], s37 offen lds
    s_add_u32 s37, s37, 2048
    s_mov_b32 exec_hi, -1
    s_lshl_b32 s38, s43, 12
    s_add_u32 s38, s38, 70144
    s_mov_b32 s56, s35
    s_mov_b32 m0, s38
    s_add_u32 s38, s38, 1024
    buffer_load_dwordx4 v2, s[16:19], s56 offen lds
    s_mov_b32 m0, s38
    s_add_u32 s38, s38, 1024
    buffer_load_dwordx4 v3, s[16:19], s56 offen lds
    s_mov_b32 m0, s38
    s_add_u32 s38, s38, 1024
    s_add_u32 s56, s56, 16384
    buffer_load_dwordx4 v2, s[16:19], s56 offen lds
    s_mov_b32 m0, s38
    s_add_u32 s38, s38, 13312
    buffer_load_dwordx4 v3, s[16:19], s56 offen lds
    s_add_u32 s35, s35, 128
    s_mov_b32 s57, s36
    s_mov_b32 m0, s38
    s_add_u32 s38, s38, 1024
    buffer_load_dwordx4 v4, s[20:23], s57 offen lds
    s_lshl_b32 s33, s31, 3
    s_add_u32 s57, s57, s33
    s_mov_b32 m0, s38
    s_add_u32 s38, s38, 1024
    buffer_load_dwordx4 v4, s[20:23], s57 offen lds
    s_lshl_b32 s33, s31, 3
    s_add_u32 s57, s57, s33
    s_mov_b32 m0, s38
    s_add_u32 s38, s38, 1024
    buffer_load_dwordx4 v4, s[20:23], s57 offen lds
    s_lshl_b32 s33, s31, 3
    s_add_u32 s57, s57, s33
    s_mov_b32 m0, s38
    s_add_u32 s38, s38, 1024
    buffer_load_dwordx4 v4, s[20:23], s57 offen lds
    s_lshl_b32 s33, s31, 6
    s_add_u32 s36, s36, s33
    s_lshl_b32 s32, s43, 9
    s_add_u32 s32, s32, 102912
    s_mov_b32 m0, s32
    s_mov_b32 exec_hi, 0
    buffer_load_dwordx4 v5, s[24:27], s37 offen lds
    s_add_u32 s37, s37, 2048
    s_mov_b32 exec_hi, -1
    v_mov_b32 v16, 13639680
    buffer_load_dword v22, v16, s[8:11], 0 offen sc1
    v_and_b32 v16, 15, v1
    v_lshrrev_b32 v17, 4, v1
    v_bfe_u32 v18, v1, 1, 3
    v_xor_b32 v18, v18, v17
    v_lshlrev_b32 v18, 4, v18
    v_lshl_add_u32 v20, v16, 7, v18
    s_lshl_b32 s32, s43, 12
    v_add_u32 v20, s32, v20
    v_bfe_u32 v16, v1, 2, 2
    v_lshl_add_u32 v16, v17, 3, v16
    v_lshlrev_b32 v16, 5, v16
    v_and_b32 v18, 3, v1
    v_lshl_add_u32 v21, v18, 3, v16
    v_add_u32 v21, 32768, v21
    v_lshlrev_b32 v6, 4, v17
    v_add_u32 v6, 34816, v6
    v_mov_b32 v56, 0
    v_mov_b32 v57, 0
    v_mov_b32 v58, 0
    v_mov_b32 v59, 0
    v_mov_b32 v60, 0
    v_mov_b32 v61, 0
    v_mov_b32 v62, 0
    v_mov_b32 v63, 0
    v_mov_b32 v64, 0
    v_mov_b32 v65, 0
    v_mov_b32 v66, 0
    v_mov_b32 v67, 0
    v_mov_b32 v68, 0
    v_mov_b32 v69, 0
    v_mov_b32 v70, 0
    v_mov_b32 v71, 0
    s_waitcnt vmcnt(19)
    s_barrier
    v_add_u32 v16, 0, v20
    ds_read_b128 v[24:27], v16
    ds_read_b128 v[28:31], v16 offset:2048
    v_add_u32 v17, 0, v21
    ds_read_b64_tr_b16 v[40:41], v17
    ds_read_b64_tr_b16 v[42:43], v17 offset:128
    v_add_u32 v16, 0, v20
    v_xor_b32 v16, 64, v16
    ds_read_b128 v[32:35], v16
    ds_read_b128 v[36:39], v16 offset:2048
    v_add_u32 v17, 1024, v21
    ds_read_b64_tr_b16 v[44:45], v17
    ds_read_b64_tr_b16 v[46:47], v17 offset:128
    s_lshl_b32 s38, s43, 12
    s_add_u32 s38, s38, 105216
    s_mov_b32 s56, s35
    s_mov_b32 m0, s38
    s_add_u32 s38, s38, 1024
    buffer_load_dwordx4 v2, s[16:19], s56 offen lds
    s_mov_b32 m0, s38
    s_add_u32 s38, s38, 1024
    buffer_load_dwordx4 v3, s[16:19], s56 offen lds
    s_mov_b32 m0, s38
    s_add_u32 s38, s38, 1024
    s_add_u32 s56, s56, 16384
    buffer_load_dwordx4 v2, s[16:19], s56 offen lds
    s_mov_b32 m0, s38
    s_add_u32 s38, s38, 13312
    buffer_load_dwordx4 v3, s[16:19], s56 offen lds
    s_add_u32 s35, s35, 128
    s_mov_b32 s57, s36
    s_mov_b32 m0, s38
    s_add_u32 s38, s38, 1024
    buffer_load_dwordx4 v4, s[20:23], s57 offen lds
    s_lshl_b32 s33, s31, 3
    s_add_u32 s57, s57, s33
    s_mov_b32 m0, s38
    s_add_u32 s38, s38, 1024
    buffer_load_dwordx4 v4, s[20:23], s57 offen lds
    s_lshl_b32 s33, s31, 3
    s_add_u32 s57, s57, s33
    s_mov_b32 m0, s38
    s_add_u32 s38, s38, 1024
    buffer_load_dwordx4 v4, s[20:23], s57 offen lds
    s_lshl_b32 s33, s31, 3
    s_add_u32 s57, s57, s33
    s_mov_b32 m0, s38
    s_add_u32 s38, s38, 1024
    buffer_load_dwordx4 v4, s[20:23], s57 offen lds
    s_lshl_b32 s33, s31, 6
    s_add_u32 s36, s36, s33
    s_lshl_b32 s32, s43, 9
    s_add_u32 s32, s32, 137984
    s_mov_b32 m0, s32
    s_mov_b32 exec_hi, 0
    buffer_load_dwordx4 v5, s[24:27], s37 offen lds
    s_add_u32 s37, s37, 2048
    s_mov_b32 exec_hi, -1
    s_waitcnt lgkmcnt(0)
    v_mfma_f32_16x16x32_bf16 v[56:59], v[24:27], v[40:43], v[56:59]
    v_mfma_f32_16x16x32_bf16 v[60:63], v[28:31], v[40:43], v[60:63]
    v_mfma_f32_16x16x32_bf16 v[56:59], v[32:35], v[44:47], v[56:59]
    v_mfma_f32_16x16x32_bf16 v[60:63], v[36:39], v[44:47], v[60:63]
    s_waitcnt vmcnt(18)
    s_barrier
    v_add_u32 v16, 35072, v20
    ds_read_b128 v[24:27], v16
    ds_read_b128 v[28:31], v16 offset:2048
    v_add_u32 v17, 35072, v21
    ds_read_b64_tr_b16 v[40:41], v17
    ds_read_b64_tr_b16 v[42:43], v17 offset:128
    v_add_u32 v16, 35072, v20
    v_xor_b32 v16, 64, v16
    ds_read_b128 v[32:35], v16
    ds_read_b128 v[36:39], v16 offset:2048
    v_add_u32 v17, 36096, v21
    ds_read_b64_tr_b16 v[44:45], v17
    ds_read_b64_tr_b16 v[46:47], v17 offset:128
    s_lshl_b32 s38, s43, 12
    s_add_u32 s38, s38, 0
    s_mov_b32 s56, s35
    s_mov_b32 m0, s38
    s_add_u32 s38, s38, 1024
    buffer_load_dwordx4 v2, s[16:19], s56 offen lds
    s_mov_b32 m0, s38
    s_add_u32 s38, s38, 1024
    buffer_load_dwordx4 v3, s[16:19], s56 offen lds
    s_mov_b32 m0, s38
    s_add_u32 s38, s38, 1024
    s_add_u32 s56, s56, 16384
    buffer_load_dwordx4 v2, s[16:19], s56 offen lds
    s_mov_b32 m0, s38
    s_add_u32 s38, s38, 13312
    buffer_load_dwordx4 v3, s[16:19], s56 offen lds
    s_add_u32 s35, s35, 128
    s_mov_b32 s57, s36
    s_mov_b32 m0, s38
    s_add_u32 s38, s38, 1024
    buffer_load_dwordx4 v4, s[20:23], s57 offen lds
    s_lshl_b32 s33, s31, 3
    s_add_u32 s57, s57, s33
    s_mov_b32 m0, s38
    s_add_u32 s38, s38, 1024
    buffer_load_dwordx4 v4, s[20:23], s57 offen lds
    s_lshl_b32 s33, s31, 3
    s_add_u32 s57, s57, s33
    s_mov_b32 m0, s38
    s_add_u32 s38, s38, 1024
    buffer_load_dwordx4 v4, s[20:23], s57 offen lds
    s_lshl_b32 s33, s31, 3
    s_add_u32 s57, s57, s33
    s_mov_b32 m0, s38
    s_add_u32 s38, s38, 1024
    buffer_load_dwordx4 v4, s[20:23], s57 offen lds
    s_lshl_b32 s33, s31, 6
    s_add_u32 s36, s36, s33
    s_lshl_b32 s32, s43, 9
    s_add_u32 s32, s32, 32768
    s_mov_b32 m0, s32
    s_mov_b32 exec_hi, 0
    buffer_load_dwordx4 v5, s[24:27], s37 offen lds
    s_add_u32 s37, s37, 2048
    s_mov_b32 exec_hi, -1
    s_waitcnt lgkmcnt(0)
    v_mfma_f32_16x16x32_bf16 v[56:59], v[24:27], v[40:43], v[56:59]
    v_mfma_f32_16x16x32_bf16 v[60:63], v[28:31], v[40:43], v[60:63]
    v_mfma_f32_16x16x32_bf16 v[56:59], v[32:35], v[44:47], v[56:59]
    v_mfma_f32_16x16x32_bf16 v[60:63], v[36:39], v[44:47], v[60:63]
    s_waitcnt vmcnt(18)
    s_barrier
    v_add_u32 v16, 70144, v20
    ds_read_b128 v[24:27], v16
    ds_read_b128 v[28:31], v16 offset:2048
    v_add_u32 v17, 70144, v21
    ds_read_b64_tr_b16 v[40:41], v17
    ds_read_b64_tr_b16 v[42:43], v17 offset:128
    v_add_u32 v16, 70144, v20
    v_xor_b32 v16, 64, v16
    ds_read_b128 v[32:35], v16
    ds_read_b128 v[36:39], v16 offset:2048
    v_add_u32 v17, 71168, v21
    ds_read_b64_tr_b16 v[44:45], v17
    ds_read_b64_tr_b16 v[46:47], v17 offset:128
    s_lshl_b32 s38, s43, 12
    s_add_u32 s38, s38, 35072
    s_mov_b32 s56, s35
    s_mov_b32 m0, s38
    s_add_u32 s38, s38, 1024
    buffer_load_dwordx4 v2, s[16:19], s56 offen lds
    s_mov_b32 m0, s38
    s_add_u32 s38, s38, 1024
    buffer_load_dwordx4 v3, s[16:19], s56 offen lds
    s_mov_b32 m0, s38
    s_add_u32 s38, s38, 1024
    s_add_u32 s56, s56, 16384
    buffer_load_dwordx4 v2, s[16:19], s56 offen lds
    s_mov_b32 m0, s38
    s_add_u32 s38, s38, 13312
    buffer_load_dwordx4 v3, s[16:19], s56 offen lds
    s_add_u32 s35, s35, 128
    s_mov_b32 s57, s36
    s_mov_b32 m0, s38
    s_add_u32 s38, s38, 1024
    buffer_load_dwordx4 v4, s[20:23], s57 offen lds
    s_lshl_b32 s33, s31, 3
    s_add_u32 s57, s57, s33
    s_mov_b32 m0, s38
    s_add_u32 s38, s38, 1024
    buffer_load_dwordx4 v4, s[20:23], s57 offen lds
    s_lshl_b32 s33, s31, 3
    s_add_u32 s57, s57, s33
    s_mov_b32 m0, s38
    s_add_u32 s38, s38, 1024
    buffer_load_dwordx4 v4, s[20:23], s57 offen lds
    s_lshl_b32 s33, s31, 3
    s_add_u32 s57, s57, s33
    s_mov_b32 m0, s38
    s_add_u32 s38, s38, 1024
    buffer_load_dwordx4 v4, s[20:23], s57 offen lds
    s_lshl_b32 s33, s31, 6
    s_add_u32 s36, s36, s33
    s_lshl_b32 s32, s43, 9
    s_add_u32 s32, s32, 67840
    s_mov_b32 m0, s32
    s_mov_b32 exec_hi, 0
    buffer_load_dwordx4 v5, s[24:27], s37 offen lds
    s_add_u32 s37, s37, 2048
    s_mov_b32 exec_hi, -1
    v_readfirstlane_b32 s12, v22
    s_nop 1
    s_add_u32 s59, s59, 1
    s_add_u32 s12, s12, 0x9e3779b9
    s_add_u32 s59, s59, s12
    s_waitcnt lgkmcnt(0)
    v_mfma_f32_16x16x32_bf16 v[56:59], v[24:27], v[40:43], v[56:59]
    v_mfma_f32_16x16x32_bf16 v[60:63], v[28:31], v[40:43], v[60:63]
    v_mfma_f32_16x16x32_bf16 v[56:59], v[32:35], v[44:47], v[56:59]
    v_mfma_f32_16x16x32_bf16 v[60:63], v[36:39], v[44:47], v[60:63]
    s_waitcnt vmcnt(18)
    s_barrier
    v_add_u32 v16, 105216, v20
    ds_read_b128 v[24:27], v16
    ds_read_b128 v[28:31], v16 offset:2048
    v_add_u32 v17, 105216, v21
    ds_read_b64_tr_b16 v[40:41], v17
    ds_read_b64_tr_b16 v[42:43], v17 offset:128
    v_add_u32 v16, 105216, v20
    v_xor_b32 v16, 64, v16
    ds_read_b128 v[32:35], v16
    ds_read_b128 v[36:39], v16 offset:2048
    v_add_u32 v17, 106240, v21
    ds_read_b64_tr_b16 v[44:45], v17
    ds_read_b64_tr_b16 v[46:47], v17 offset:128
    s_lshl_b32 s38, s43, 12
    s_add_u32 s38, s38, 70144
    s_mov_b32 s56, s35
    s_mov_b32 m0, s38
    s_add_u32 s38, s38, 1024
    buffer_load_dwordx4 v2, s[16:19], s56 offen lds
    s_mov_b32 m0, s38
    s_add_u32 s38, s38, 1024
    buffer_load_dwordx4 v3, s[16:19], s56 offen lds
    s_mov_b32 m0, s38
    s_add_u32 s38, s38, 1024
    s_add_u32 s56, s56, 16384
    buffer_load_dwordx4 v2, s[16:19], s56 offen lds
    s_mov_b32 m0, s38
    s_add_u32 s38, s38, 13312
    buffer_load_dwordx4 v3, s[16:19], s56 offen lds
    s_add_u32 s35, s35, 128
    s_mov_b32 s57, s36
    s_mov_b32 m0, s38
    s_add_u32 s38, s38, 1024
    buffer_load_dwordx4 v4, s[20:23], s57 offen lds
    s_lshl_b32 s33, s31, 3
    s_add_u32 s57, s57, s33
    s_mov_b32 m0, s38
    s_add_u32 s38, s38, 1024
    buffer_load_dwordx4 v4, s[20:23], s57 offen lds
    s_lshl_b32 s33, s31, 3
    s_add_u32 s57, s57, s33
    s_mov_b32 m0, s38
    s_add_u32 s38, s38, 1024
    buffer_load_dwordx4 v4, s[20:23], s57 offen lds
    s_lshl_b32 s33, s31, 3
    s_add_u32 s57, s57, s33
    s_mov_b32 m0, s38
    s_add_u32 s38, s38, 1024
    buffer_load_dwordx4 v4, s[20:23], s57 offen lds
    s_lshl_b32 s33, s31, 6
    s_add_u32 s36, s36, s33
    s_lshl_b32 s32, s43, 9
    s_add_u32 s32, s32, 102912
    s_mov_b32 m0, s32
    s_mov_b32 exec_hi, 0
    buffer_load_dwordx4 v5, s[24:27], s37 offen lds
    s_add_u32 s37, s37, 2048
    s_mov_b32 exec_hi, -1
    s_waitcnt lgkmcnt(0)
    v_mfma_f32_16x16x32_bf16 v[56:59], v[24:27], v[40:43], v[56:59]
    v_mfma_f32_16x16x32_bf16 v[60:63], v[28:31], v[40:43], v[60:63]
    v_mfma_f32_16x16x32_bf16 v[56:59], v[32:35], v[44:47], v[56:59]
    v_mfma_f32_16x16x32_bf16 v[60:63], v[36:39], v[44:47], v[60:63]
    s_waitcnt vmcnt(18)
    s_barrier
    v_add_u32 v16, 0, v20
    ds_read_b128 v[24:27], v16
    ds_read_b128 v[28:31], v16 offset:2048
    v_add_u32 v17, 0, v21
    ds_read_b64_tr_b16 v[40:41], v17
    ds_read_b64_tr_b16 v[42:43], v17 offset:128
    v_add_u32 v16, 0, v20
    v_xor_b32 v16, 64, v16
    ds_read_b128 v[32:35], v16
    ds_read_b128 v[36:39], v16 offset:2048
    v_add_u32 v17, 1024, v21
    ds_read_b64_tr_b16 v[44:45], v17
    ds_read_b64_tr_b16 v[46:47], v17 offset:128
    s_lshl_b32 s38, s43, 12
    s_add_u32 s38, s38, 105216
    s_mov_b32 s56, s35
    s_mov_b32 m0, s38
    s_add_u32 s38, s38, 1024
    buffer_load_dwordx4 v2, s[16:19], s56 offen lds
    s_mov_b32 m0, s38
    s_add_u32 s38, s38, 1024
    buffer_load_dwordx4 v3, s[16:19], s56 offen lds
    s_mov_b32 m0, s38
    s_add_u32 s38, s38, 1024
    s_add_u32 s56, s56, 16384
    buffer_load_dwordx4 v2, s[16:19], s56 offen lds
    s_mov_b32 m0, s38
    s_add_u32 s38, s38, 13312
    buffer_load_dwordx4 v3, s[16:19], s56 offen lds
    s_add_u32 s35, s35, 128
    s_mov_b32 s57, s36
    s_mov_b32 m0, s38
    s_add_u32 s38, s38, 1024
    buffer_load_dwordx4 v4, s[20:23], s57 offen lds
    s_lshl_b32 s33, s31, 3
    s_add_u32 s57, s57, s33
    s_mov_b32 m0, s38
    s_add_u32 s38, s38, 1024
    buffer_load_dwordx4 v4, s[20:23], s57 offen lds
    s_lshl_b32 s33, s31, 3
    s_add_u32 s57, s57, s33
    s_mov_b32 m0, s38
    s_add_u32 s38, s38, 1024
    buffer_load_dwordx4 v4, s[20:23], s57 offen lds
    s_lshl_b32 s33, s31, 3
    s_add_u32 s57, s57, s33
    s_mov_b32 m0, s38
    s_add_u32 s38, s38, 1024
    buffer_load_dwordx4 v4, s[20:23], s57 offen lds
    s_lshl_b32 s33, s31, 6
    s_add_u32 s36, s36, s33
    s_lshl_b32 s32, s43, 9
    s_add_u32 s32, s32, 137984
    s_mov_b32 m0, s32
    s_mov_b32 exec_hi, 0
    buffer_load_dwordx4 v5, s[24:27], s37 offen lds
    s_add_u32 s37, s37, 2048
    s_mov_b32 exec_hi, -1
    s_waitcnt lgkmcnt(0)
    v_mfma_f32_16x16x32_bf16 v[56:59], v[24:27], v[40:43], v[56:59]
    v_mfma_f32_16x16x32_bf16 v[60:63], v[28:31], v[40:43], v[60:63]
    v_mfma_f32_16x16x32_bf16 v[56:59], v[32:35], v[44:47], v[56:59]
    v_mfma_f32_16x16x32_bf16 v[60:63], v[36:39], v[44:47], v[60:63]
    s_waitcnt vmcnt(18)
    s_barrier
    v_add_u32 v16, 35072, v20
    ds_read_b128 v[24:27], v16
    ds_read_b128 v[28:31], v16 offset:2048
    v_add_u32 v17, 35072, v21
    ds_read_b64_tr_b16 v[40:41], v17
    ds_read_b64_tr_b16 v[42:43], v17 offset:128
    v_add_u32 v16, 35072, v20
    v_xor_b32 v16, 64, v16
    ds_read_b128 v[32:35], v16
    ds_read_b128 v[36:39], v16 offset:2048
    v_add_u32 v17, 36096, v21
    ds_read_b64_tr_b16 v[44:45], v17
    ds_read_b64_tr_b16 v[46:47], v17 offset:128
    v_and_b32 v16, 31, v1
    v_lshlrev_b32 v16, 2, v16
    s_lshl_b32 s32, s29, 7
    s_add_u32 s32, s32, 13647872
    buffer_load_dword v128, v16, s[8:11], s32 offen sc1
    s_waitcnt lgkmcnt(0)
    v_mfma_f32_16x16x32_bf16 v[56:59], v[24:27], v[40:43], v[56:59]
    v_mfma_f32_16x16x32_bf16 v[60:63], v[28:31], v[40:43], v[60:63]
    v_mfma_f32_16x16x32_bf16 v[56:59], v[32:35], v[44:47], v[56:59]
    v_mfma_f32_16x16x32_bf16 v[60:63], v[36:39], v[44:47], v[60:63]
    s_waitcnt vmcnt(10)
    s_barrier
    v_add_u32 v16, 70144, v20
    ds_read_b128 v[24:27], v16
    ds_read_b128 v[28:31], v16 offset:2048
    v_add_u32 v17, 70144, v21
    ds_read_b64_tr_b16 v[40:41], v17
    ds_read_b64_tr_b16 v[42:43], v17 offset:128
    v_add_u32 v16, 70144, v20
    v_xor_b32 v16, 64, v16
    ds_read_b128 v[32:35], v16
    ds_read_b128 v[36:39], v16 offset:2048
    v_add_u32 v17, 71168, v21
    ds_read_b64_tr_b16 v[44:45], v17
    ds_read_b64_tr_b16 v[46:47], v17 offset:128
    s_waitcnt lgkmcnt(0)
    v_mfma_f32_16x16x32_bf16 v[56:59], v[24:27], v[40:43], v[56:59]
    v_mfma_f32_16x16x32_bf16 v[60:63], v[28:31], v[40:43], v[60:63]
    v_mfma_f32_16x16x32_bf16 v[56:59], v[32:35], v[44:47], v[56:59]
    v_mfma_f32_16x16x32_bf16 v[60:63], v[36:39], v[44:47], v[60:63]
    s_waitcnt vmcnt(1)
    s_barrier
    v_add_u32 v16, 105216, v20
    ds_read_b128 v[24:27], v16
    ds_read_b128 v[28:31], v16 offset:2048
    v_add_u32 v17, 105216, v21
    ds_read_b64_tr_b16 v[40:41], v17
    ds_read_b64_tr_b16 v[42:43], v17 offset:128
    v_add_u32 v16, 105216, v20
    v_xor_b32 v16, 64, v16
    ds_read_b128 v[32:35], v16
    ds_read_b128 v[36:39], v16 offset:2048
    v_add_u32 v17, 106240, v21
    ds_read_b64_tr_b16 v[44:45], v17
    ds_read_b64_tr_b16 v[46:47], v17 offset:128
    s_waitcnt lgkmcnt(0)
    v_mfma_f32_16x16x32_bf16 v[56:59], v[24:27], v[40:43], v[56:59]
    v_mfma_f32_16x16x32_bf16 v[60:63], v[28:31], v[40:43], v[60:63]
    v_mfma_f32_16x16x32_bf16 v[56:59], v[32:35], v[44:47], v[56:59]
    v_mfma_f32_16x16x32_bf16 v[60:63], v[36:39], v[44:47], v[60:63]
    s_waitcnt vmcnt(0)
    v_cmp_eq_u32 s[66:67], s59, v128
    s_lshl_b32 s32, s28, 2
    s_add_u32 s32, s32, s43
    v_and_b32 v16, 15, v1
    v_lshrrev_b32 v17, 4, v1
    v_and_b32 v18, 1, v17
    v_lshrrev_b32 v19, 1, v17
    s_add_u32 s33, s29, 32
    s_lshl_b32 s33, s33, 16
    s_lshl_b32 s34, s32, 10
    s_add_u32 s33, s33, s34
    v_lshlrev_b32 v21, 4, v16
    v_lshl_add_u32 v21, v18, 8, v21
    v_lshl_add_u32 v21, v19, 3, v21
    s_add_u32 s33, s33, 6815744
    s_nop 3
    v_cvt_pk_bf16_f32 v24, v56, v57
    v_cvt_pk_bf16_f32 v25, v58, v59
    v_cvt_pk_bf16_f32 v32, v60, v61
    v_cvt_pk_bf16_f32 v33, v62, v63
    s_cmp_eq_u64 s[66:67], -1
    s_cbranch_scc1 PJ_md3_fast
    buffer_store_dwordx2 v[24:25], v21, s[8:11], s33 offen offset:0 sc1
    buffer_store_dwordx2 v[32:33], v21, s[8:11], s33 offen offset:512 sc1
    s_branch PJ_md3_done
PJ_md3_fast:
    buffer_store_dwordx2 v[24:25], v21, s[8:11], s33 offen offset:0
    buffer_store_dwordx2 v[32:33], v21, s[8:11], s33 offen offset:512
PJ_md3_done:
    s_branch PJ_end
PJ_comp:
    s_lshr_b32 s32, s3, 1
    s_lshl_b32 s58, s30, 1
    s_add_u32 s58, s58, s32
    v_and_b32 v16, 31, v1
    v_lshrrev_b32 v17, 5, v1
    v_bfe_u32 v18, v1, 1, 3
    s_and_b32 s32, s3, 1
    s_lshl_b32 s32, s32, 13
    v_lshlrev_b32 v16, 7, v16
    v_add_u32 v16, s32, v16
    v_add_u32 v19, 0, v17
    v_xor_b32 v19, v19, v18
    v_lshl_add_u32 v6, v19, 4, v16
    v_add_u32 v10, 70144, v6
    v_add_u32 v19, 2, v17
    v_xor_b32 v19, v19, v18
    v_lshl_add_u32 v7, v19, 4, v16
    v_add_u32 v11, 70144, v7
    v_add_u32 v19, 4, v17
    v_xor_b32 v19, v19, v18
    v_lshl_add_u32 v8, v19, 4, v16
    v_add_u32 v12, 70144, v8
    v_add_u32 v19, 6, v17
    v_xor_b32 v19, v19, v18
    v_lshl_add_u32 v9, v19, 4, v16
    v_add_u32 v13, 70144, v9
    v_lshlrev_b32 v17, 10, v17
    v_bfe_u32 v18, v1, 2, 2
    v_lshl_add_u32 v17, v18, 6, v17
    v_bfe_u32 v18, v1, 4, 1
    v_lshl_add_u32 v17, v18, 5, v17
    v_and_b32 v18, 3, v1
    v_lshl_add_u32 v17, v18, 3, v17
    s_lshr_b32 s32, s3, 1
    s_lshl_b32 s32, s32, 13
    s_add_u32 s32, s32, 16384
    v_add_u32 v14, s32, v17
    v_add_u32 v15, 70144, v14
    v_mov_b32 v64, 0
    v_mov_b32 v65, 0
    v_mov_b32 v66, 0
    v_mov_b32 v67, 0
    v_mov_b32 v68, 0
    v_mov_b32 v69, 0
    v_mov_b32 v70, 0
    v_mov_b32 v71, 0
    v_mov_b32 v72, 0
    v_mov_b32 v73, 0
    v_mov_b32 v74, 0
    v_mov_b32 v75, 0
    v_mov_b32 v76, 0
    v_mov_b32 v77, 0
    v_mov_b32 v78, 0
    v_mov_b32 v79, 0
    v_mov_b32 v80, 0
    v_mov_b32 v81, 0
    v_mov_b32 v82, 0
    v_mov_b32 v83, 0
    v_mov_b32 v84, 0
    v_mov_b32 v85, 0
    v_mov_b32 v86, 0
    v_mov_b32 v87, 0
    v_mov_b32 v88, 0
    v_mov_b32 v89, 0
    v_mov_b32 v90, 0
    v_mov_b32 v91, 0
    v_mov_b32 v92, 0
    v_mov_b32 v93, 0
    v_mov_b32 v94, 0
    v_mov_b32 v95, 0
    v_mov_b32 v96, 0
    v_mov_b32 v97, 0
    v_mov_b32 v98, 0
    v_mov_b32 v99, 0
    v_mov_b32 v100, 0
    v_mov_b32 v101, 0
    v_mov_b32 v102, 0
    v_mov_b32 v103, 0
    v_mov_b32 v104, 0
    v_mov_b32 v105, 0
    v_mov_b32 v106, 0
    v_mov_b32 v107, 0
    v_mov_b32 v108, 0
    v_mov_b32 v109, 0
    v_mov_b32 v110, 0
    v_mov_b32 v111, 0
    v_mov_b32 v112, 0
    v_mov_b32 v113, 0
    v_mov_b32 v114, 0
    v_mov_b32 v115, 0
    v_mov_b32 v116, 0
    v_mov_b32 v117, 0
    v_mov_b32 v118, 0
    v_mov_b32 v119, 0
    v_mov_b32 v120, 0
    v_mov_b32 v121, 0
    v_mov_b32 v122, 0
    v_mov_b32 v123, 0
    v_mov_b32 v124, 0
    v_mov_b32 v125, 0
    v_mov_b32 v126, 0
    v_mov_b32 v127, 0
    s_waitcnt lgkmcnt(0)
    s_mov_b32 s8, s50
    s_and_b32 s9, s51, 0xffff
    s_mov_b32 s10, 0x1000000
    s_mov_b32 s11, 0x00020000
    v_mov_b32 v16, 13639680
    buffer_load_dword v22, v16, s[8:11], 0 offen sc1
    s_lshl_b32 s32, s29, 2
    s_cmp_eq_u32 s58, 3
    s_cselect_b32 s33, 32, 0
    s_add_u32 s32, s32, s33
    s_lshl_b32 s32, s32, 16
    s_lshl_b32 s33, s28, 2
    s_and_b32 s34, s3, 1
    s_lshl_b32 s34, s34, 1
    s_add_u32 s33, s33, s34
    s_lshl_b32 s33, s33, 10
    s_add_u32 s52, s32, s33
    s_cmp_eq_u32 s58, 2
    s_cbranch_scc1 PJ_vt
    v_and_b32 v16, 31, v1
    v_and_b32 v17, 0x13, v16
    v_bfe_u32 v18, v16, 2, 1
    v_lshl_or_b32 v17, v18, 3, v17
    v_bfe_u32 v18, v16, 3, 1
    v_lshl_or_b32 v17, v18, 2, v17
    s_cmp_eq_u32 s58, 1
    s_cselect_b64 vcc, -1, 0
    v_cndmask_b32 v16, v16, v17, vcc
    v_lshrrev_b32 v17, 5, v1
    v_lshlrev_b32 v17, 9, v17
    v_lshl_add_u32 v23, v16, 4, v17
    s_mov_b32 s34, 0
    s_cselect_b32 s34, 4194304, s34
    s_mov_b32 s54, 0x3eb8aa3b
    s_cselect_b32 s54, 1.0, s54
    s_mov_b32 s55, s54
    s_add_u32 s52, s52, s34
    s_barrier
    ds_read_b128 v[24:27], v6 offset:0
    ds_read_b64_tr_b16 v[40:41], v14 offset:0
    ds_read_b64_tr_b16 v[42:43], v14 offset:512
    ds_read_b128 v[28:31], v6 offset:4096
    ds_read_b64_tr_b16 v[44:45], v14 offset:256
    ds_read_b64_tr_b16 v[46:47], v14 offset:768
    ds_read_b128 v[32:35], v7 offset:0
    ds_read_b64_tr_b16 v[48:49], v14 offset:2048
    ds_read_b64_tr_b16 v[50:51], v14 offset:2560
    ds_read_b128 v[36:39], v7 offset:4096
    ds_read_b64_tr_b16 v[52:53], v14 offset:2304
    ds_read_b64_tr_b16 v[54:55], v14 offset:2816
    s_waitcnt lgkmcnt(6)
    v_mfma_f32_32x32x16_bf16 v[64:79], v[40:43], v[24:27], v[64:79]
    v_mfma_f32_32x32x16_bf16 v[80:95], v[40:43], v[28:31], v[80:95]
    v_mfma_f32_32x32x16_bf16 v[96:111], v[44:47], v[24:27], v[96:111]
    v_mfma_f32_32x32x16_bf16 v[112:127], v[44:47], v[28:31], v[112:127]
    ds_read_b128 v[24:27], v8 offset:0
    ds_read_b64_tr_b16 v[40:41], v14 offset:4096
    ds_read_b64_tr_b16 v[42:43], v14 offset:4608
    ds_read_b128 v[28:31], v8 offset:4096
    ds_read_b64_tr_b16 v[44:45], v14 offset:4352
    ds_read_b64_tr_b16 v[46:47], v14 offset:4864
    s_waitcnt lgkmcnt(6)
    v_mfma_f32_32x32x16_bf16 v[64:79], v[48:51], v[32:35], v[64:79]
    v_mfma_f32_32x32x16_bf16 v[80:95], v[48:51], v[36:39], v[80:95]
    v_mfma_f32_32x32x16_bf16 v[96:111], v[52:55], v[32:35], v[96:111]
    v_mfma_f32_32x32x16_bf16 v[112:127], v[52:55], v[36:39], v[112:127]
    ds_read_b128 v[32:35], v9 offset:0
    ds_read_b64_tr_b16 v[48:49], v14 offset:6144
    ds_read_b64_tr_b16 v[50:51], v14 offset:6656
    ds_read_b128 v[36:39], v9 offset:4096
    ds_read_b64_tr_b16 v[52:53], v14 offset:6400
    ds_read_b64_tr_b16 v[54:55], v14 offset:6912
    s_waitcnt lgkmcnt(6)
    v_mfma_f32_32x32x16_bf16 v[64:79], v[40:43], v[24:27], v[64:79]
    v_mfma_f32_32x32x16_bf16 v[80:95], v[40:43], v[28:31], v[80:95]
    v_mfma_f32_32x32x16_bf16 v[96:111], v[44:47], v[24:27], v[96:111]
    v_mfma_f32_32x32x16_bf16 v[112:127], v[44:47], v[28:31], v[112:127]
    s_waitcnt lgkmcnt(0)
    s_barrier
    ds_read_b128 v[24:27], v6 offset:35072
    ds_read_b64_tr_b16 v[40:41], v14 offset:35072
    ds_read_b64_tr_b16 v[42:43], v14 offset:35584
    ds_read_b128 v[28:31], v6 offset:39168
    ds_read_b64_tr_b16 v[44:45], v14 offset:35328
    ds_read_b64_tr_b16 v[46:47], v14 offset:35840
    v_mfma_f32_32x32x16_bf16 v[64:79], v[48:51], v[32:35], v[64:79]
    v_mfma_f32_32x32x16_bf16 v[80:95], v[48:51], v[36:39], v[80:95]
    v_mfma_f32_32x32x16_bf16 v[96:111], v[52:55], v[32:35], v[96:111]
    v_mfma_f32_32x32x16_bf16 v[112:127], v[52:55], v[36:39], v[112:127]
    s_waitcnt vmcnt(0)
    v_readfirstlane_b32 s12, v22
    s_nop 1
    s_add_u32 s59, s59, 1
    s_add_u32 s12, s12, 0x9e3779b9
    s_add_u32 s59, s59, s12
    s_cmp_lg_u32 s3, 0
    s_cbranch_scc1 PJ_q_noxt
    s_lshl_b32 s32, s29, 7
    s_lshr_b32 s33, s2, 3
    s_lshl_b32 s33, s33, 2
    s_add_u32 s32, s32, s33
    s_add_u32 s32, s32, 13647872
    v_mov_b32 v16, s32
    v_mov_b32 v17, s59
    s_mov_b64 exec, 1
    buffer_store_dword v17, v16, s[8:11], 0 offen sc1
    s_mov_b64 exec, -1
PJ_q_noxt:
    ds_read_b128 v[32:35], v7 offset:35072
    ds_read_b64_tr_b16 v[48:49], v14 offset:37120
    ds_read_b64_tr_b16 v[50:51], v14 offset:37632
    ds_read_b128 v[36:39], v7 offset:39168
    ds_read_b64_tr_b16 v[52:53], v14 offset:37376
    ds_read_b64_tr_b16 v[54:55], v14 offset:37888
    s_waitcnt lgkmcnt(6)
    v_mfma_f32_32x32x16_bf16 v[64:79], v[40:43], v[24:27], v[64:79]
    v_mfma_f32_32x32x16_bf16 v[80:95], v[40:43], v[28:31], v[80:95]
    v_mfma_f32_32x32x16_bf16 v[96:111], v[44:47], v[24:27], v[96:111]
    v_mfma_f32_32x32x16_bf16 v[112:127], v[44:47], v[28:31], v[112:127]
    ds_read_b128 v[24:27], v8 offset:35072
    ds_read_b64_tr_b16 v[40:41], v14 offset:39168
    ds_read_b64_tr_b16 v[42:43], v14 offset:39680
    ds_read_b128 v[28:31], v8 offset:39168
    ds_read_b64_tr_b16 v[44:45], v14 offset:39424
    ds_read_b64_tr_b16 v[46:47], v14 offset:39936
    s_waitcnt lgkmcnt(6)
    v_mfma_f32_32x32x16_bf16 v[64:79], v[48:51], v[32:35], v[64:79]
    v_mfma_f32_32x32x16_bf16 v[80:95], v[48:51], v[36:39], v[80:95]
    v_mfma_f32_32x32x16_bf16 v[96:111], v[52:55], v[32:35], v[96:111]
    v_mfma_f32_32x32x16_bf16 v[112:127], v[52:55], v[36:39], v[112:127]
    ds_read_b128 v[32:35], v9 offset:35072
    ds_read_b64_tr_b16 v[48:49], v14 offset:41216
    ds_read_b64_tr_b16 v[50:51], v14 offset:41728
    ds_read_b128 v[36:39], v9 offset:39168
    ds_read_b64_tr_b16 v[52:53], v14 offset:41472
    ds_read_b64_tr_b16 v[54:55], v14 offset:41984
    s_waitcnt lgkmcnt(6)
    v_mfma_f32_32x32x16_bf16 v[64:79], v[40:43], v[24:27], v[64:79]
    v_mfma_f32_32x32x16_bf16 v[80:95], v[40:43], v[28:31], v[80:95]
    v_mfma_f32_32x32x16_bf16 v[96:111], v[44:47], v[24:27], v[96:111]
    v_mfma_f32_32x32x16_bf16 v[112:127], v[44:47], v[28:31], v[112:127]
    s_waitcnt lgkmcnt(0)
    s_barrier
    ds_read_b128 v[24:27], v10 offset:0
    ds_read_b64_tr_b16 v[40:41], v15 offset:0
    ds_read_b64_tr_b16 v[42:43], v15 offset:512
    ds_read_b128 v[28:31], v10 offset:4096
    ds_read_b64_tr_b16 v[44:45], v15 offset:256
    ds_read_b64_tr_b16 v[46:47], v15 offset:768
    v_mfma_f32_32x32x16_bf16 v[64:79], v[48:51], v[32:35], v[64:79]
    v_mfma_f32_32x32x16_bf16 v[80:95], v[48:51], v[36:39], v[80:95]
    v_mfma_f32_32x32x16_bf16 v[96:111], v[52:55], v[32:35], v[96:111]
    v_mfma_f32_32x32x16_bf16 v[112:127], v[52:55], v[36:39], v[112:127]
    ds_read_b128 v[32:35], v11 offset:0
    ds_read_b64_tr_b16 v[48:49], v15 offset:2048
    ds_read_b64_tr_b16 v[50:51], v15 offset:2560
    ds_read_b128 v[36:39], v11 offset:4096
    ds_read_b64_tr_b16 v[52:53], v15 offset:2304
    ds_read_b64_tr_b16 v[54:55], v15 offset:2816
    s_waitcnt lgkmcnt(6)
    v_mfma_f32_32x32x16_bf16 v[64:79], v[40:43], v[24:27], v[64:79]
    v_mfma_f32_32x32x16_bf16 v[80:95], v[40:43], v[28:31], v[80:95]
    v_mfma_f32_32x32x16_bf16 v[96:111], v[44:47], v[24:27], v[96:111]
    v_mfma_f32_32x32x16_bf16 v[112:127], v[44:47], v[28:31], v[112:127]
    ds_read_b128 v[24:27], v12 offset:0
    ds_read_b64_tr_b16 v[40:41], v15 offset:4096
    ds_read_b64_tr_b16 v[42:43], v15 offset:4608
    ds_read_b128 v[28:31], v12 offset:4096
    ds_read_b64_tr_b16 v[44:45], v15 offset:4352
    ds_read_b64_tr_b16 v[46:47], v15 offset:4864
    s_waitcnt lgkmcnt(6)
    v_mfma_f32_32x32x16_bf16 v[64:79], v[48:51], v[32:35], v[64:79]
    v_mfma_f32_32x32x16_bf16 v[80:95], v[48:51], v[36:39], v[80:95]
    v_mfma_f32_32x32x16_bf16 v[96:111], v[52:55], v[32:35], v[96:111]
    v_mfma_f32_32x32x16_bf16 v[112:127], v[52:55], v[36:39], v[112:127]
    ds_read_b128 v[32:35], v13 offset:0
    ds_read_b64_tr_b16 v[48:49], v15 offset:6144
    ds_read_b64_tr_b16 v[50:51], v15 offset:6656
    ds_read_b128 v[36:39], v13 offset:4096
    ds_read_b64_tr_b16 v[52:53], v15 offset:6400
    ds_read_b64_tr_b16 v[54:55], v15 offset:6912
    s_waitcnt lgkmcnt(6)
    v_mfma_f32_32x32x16_bf16 v[64:79], v[40:43], v[24:27], v[64:79]
    v_mfma_f32_32x32x16_bf16 v[80:95], v[40:43], v[28:31], v[80:95]
    v_mfma_f32_32x32x16_bf16 v[96:111], v[44:47], v[24:27], v[96:111]
    v_mfma_f32_32x32x16_bf16 v[112:127], v[44:47], v[28:31], v[112:127]
    s_waitcnt lgkmcnt(0)
    s_barrier
    ds_read_b128 v[24:27], v10 offset:35072
    ds_read_b64_tr_b16 v[40:41], v15 offset:35072
    ds_read_b64_tr_b16 v[42:43], v15 offset:35584
    ds_read_b128 v[28:31], v10 offset:39168
    ds_read_b64_tr_b16 v[44:45], v15 offset:35328
    ds_read_b64_tr_b16 v[46:47], v15 offset:35840
    v_mfma_f32_32x32x16_bf16 v[64:79], v[48:51], v[32:35], v[64:79]
    v_mfma_f32_32x32x16_bf16 v[80:95], v[48:51], v[36:39], v[80:95]
    v_mfma_f32_32x32x16_bf16 v[96:111], v[52:55], v[32:35], v[96:111]
    v_mfma_f32_32x32x16_bf16 v[112:127], v[52:55], v[36:39], v[112:127]
    ds_read_b128 v[32:35], v11 offset:35072
    ds_read_b64_tr_b16 v[48:49], v15 offset:37120
    ds_read_b64_tr_b16 v[50:51], v15 offset:37632
    ds_read_b128 v[36:39], v11 offset:39168
    ds_read_b64_tr_b16 v[52:53], v15 offset:37376
    ds_read_b64_tr_b16 v[54:55], v15 offset:37888
    s_waitcnt lgkmcnt(6)
    v_mfma_f32_32x32x16_bf16 v[64:79], v[40:43], v[24:27], v[64:79]
    v_mfma_f32_32x32x16_bf16 v[80:95], v[40:43], v[28:31], v[80:95]
    v_mfma_f32_32x32x16_bf16 v[96:111], v[44:47], v[24:27], v[96:111]
    v_mfma_f32_32x32x16_bf16 v[112:127], v[44:47], v[28:31], v[112:127]
    ds_read_b128 v[24:27], v12 offset:35072
    ds_read_b64_tr_b16 v[40:41], v15 offset:39168
    ds_read_b64_tr_b16 v[42:43], v15 offset:39680
    ds_read_b128 v[28:31], v12 offset:39168
    ds_read_b64_tr_b16 v[44:45], v15 offset:39424
    ds_read_b64_tr_b16 v[46:47], v15 offset:39936
    s_waitcnt lgkmcnt(6)
    v_mfma_f32_32x32x16_bf16 v[64:79], v[48:51], v[32:35], v[64:79]
    v_mfma_f32_32x32x16_bf16 v[80:95], v[48:51], v[36:39], v[80:95]
    v_mfma_f32_32x32x16_bf16 v[96:111], v[52:55], v[32:35], v[96:111]
    v_mfma_f32_32x32x16_bf16 v[112:127], v[52:55], v[36:39], v[112:127]
    ds_read_b128 v[32:35], v13 offset:35072
    ds_read_b64_tr_b16 v[48:49], v15 offset:41216
    ds_read_b64_tr_b16 v[50:51], v15 offset:41728
    ds_read_b128 v[36:39], v13 offset:39168
    ds_read_b64_tr_b16 v[52:53], v15 offset:41472
    ds_read_b64_tr_b16 v[54:55], v15 offset:41984
    s_waitcnt lgkmcnt(6)
    v_mfma_f32_32x32x16_bf16 v[64:79], v[40:43], v[24:27], v[64:79]
    v_mfma_f32_32x32x16_bf16 v[80:95], v[40:43], v[28:31], v[80:95]
    v_mfma_f32_32x32x16_bf16 v[96:111], v[44:47], v[24:27], v[96:111]
    v_mfma_f32_32x32x16_bf16 v[112:127], v[44:47], v[28:31], v[112:127]
    s_waitcnt lgkmcnt(0)
    s_barrier
    ds_read_b128 v[24:27], v6 offset:0
    ds_read_b64_tr_b16 v[40:41], v14 offset:0
    ds_read_b64_tr_b16 v[42:43], v14 offset:512
    ds_read_b128 v[28:31], v6 offset:4096
    ds_read_b64_tr_b16 v[44:45], v14 offset:256
    ds_read_b64_tr_b16 v[46:47], v14 offset:768
    v_mfma_f32_32x32x16_bf16 v[64:79], v[48:51], v[32:35], v[64:79]
    v_mfma_f32_32x32x16_bf16 v[80:95], v[48:51], v[36:39], v[80:95]
    v_mfma_f32_32x32x16_bf16 v[96:111], v[52:55], v[32:35], v[96:111]
    v_mfma_f32_32x32x16_bf16 v[112:127], v[52:55], v[36:39], v[112:127]
    ds_read_b128 v[32:35], v7 offset:0
    ds_read_b64_tr_b16 v[48:49], v14 offset:2048
    ds_read_b64_tr_b16 v[50:51], v14 offset:2560
    ds_read_b128 v[36:39], v7 offset:4096
    ds_read_b64_tr_b16 v[52:53], v14 offset:2304
    ds_read_b64_tr_b16 v[54:55], v14 offset:2816
    s_waitcnt lgkmcnt(6)
    v_mfma_f32_32x32x16_bf16 v[64:79], v[40:43], v[24:27], v[64:79]
    v_mfma_f32_32x32x16_bf16 v[80:95], v[40:43], v[28:31], v[80:95]
    v_mfma_f32_32x32x16_bf16 v[96:111], v[44:47], v[24:27], v[96:111]
    v_mfma_f32_32x32x16_bf16 v[112:127], v[44:47], v[28:31], v[112:127]
    ds_read_b128 v[24:27], v8 offset:0
    ds_read_b64_tr_b16 v[40:41], v14 offset:4096
    ds_read_b64_tr_b16 v[42:43], v14 offset:4608
    ds_read_b128 v[28:31], v8 offset:4096
    ds_read_b64_tr_b16 v[44:45], v14 offset:4352
    ds_read_b64_tr_b16 v[46:47], v14 offset:4864
    s_waitcnt lgkmcnt(6)
    v_mfma_f32_32x32x16_bf16 v[64:79], v[48:51], v[32:35], v[64:79]
    v_mfma_f32_32x32x16_bf16 v[80:95], v[48:51], v[36:39], v[80:95]
    v_mfma_f32_32x32x16_bf16 v[96:111], v[52:55], v[32:35], v[96:111]
    v_mfma_f32_32x32x16_bf16 v[112:127], v[52:55], v[36:39], v[112:127]
    ds_read_b128 v[32:35], v9 offset:0
    ds_read_b64_tr_b16 v[48:49], v14 offset:6144
    ds_read_b64_tr_b16 v[50:51], v14 offset:6656
    ds_read_b128 v[36:39], v9 offset:4096
    ds_read_b64_tr_b16 v[52:53], v14 offset:6400
    ds_read_b64_tr_b16 v[54:55], v14 offset:6912
    s_waitcnt lgkmcnt(6)
    v_mfma_f32_32x32x16_bf16 v[64:79], v[40:43], v[24:27], v[64:79]
    v_mfma_f32_32x32x16_bf16 v[80:95], v[40:43], v[28:31], v[80:95]
    v_mfma_f32_32x32x16_bf16 v[96:111], v[44:47], v[24:27], v[96:111]
    v_mfma_f32_32x32x16_bf16 v[112:127], v[44:47], v[28:31], v[112:127]
    s_waitcnt lgkmcnt(0)
    s_barrier
    ds_read_b128 v[24:27], v6 offset:35072
    ds_read_b64_tr_b16 v[40:41], v14 offset:35072
    ds_read_b64_tr_b16 v[42:43], v14 offset:35584
    ds_read_b128 v[28:31], v6 offset:39168
    ds_read_b64_tr_b16 v[44:45], v14 offset:35328
    ds_read_b64_tr_b16 v[46:47], v14 offset:35840
    v_mfma_f32_32x32x16_bf16 v[64:79], v[48:51], v[32:35], v[64:79]
    v_mfma_f32_32x32x16_bf16 v[80:95], v[48:51], v[36:39], v[80:95]
    v_mfma_f32_32x32x16_bf16 v[96:111], v[52:55], v[32:35], v[96:111]
    v_mfma_f32_32x32x16_bf16 v[112:127], v[52:55], v[36:39], v[112:127]
    v_and_b32 v16, 31, v1
    v_lshlrev_b32 v16, 2, v16
    s_lshl_b32 s32, s29, 7
    s_add_u32 s32, s32, 13647872
    buffer_load_dword v128, v16, s[8:11], s32 offen sc1
    ds_read_b128 v[32:35], v7 offset:35072
    ds_read_b64_tr_b16 v[48:49], v14 offset:37120
    ds_read_b64_tr_b16 v[50:51], v14 offset:37632
    ds_read_b128 v[36:39], v7 offset:39168
    ds_read_b64_tr_b16 v[52:53], v14 offset:37376
    ds_read_b64_tr_b16 v[54:55], v14 offset:37888
    s_waitcnt lgkmcnt(6)
    v_mfma_f32_32x32x16_bf16 v[64:79], v[40:43], v[24:27], v[64:79]
    v_mfma_f32_32x32x16_bf16 v[80:95], v[40:43], v[28:31], v[80:95]
    v_mfma_f32_32x32x16_bf16 v[96:111], v[44:47], v[24:27], v[96:111]
    v_mfma_f32_32x32x16_bf16 v[112:127], v[44:47], v[28:31], v[112:127]
    ds_read_b128 v[24:27], v8 offset:35072
    ds_read_b64_tr_b16 v[40:41], v14 offset:39168
    ds_read_b64_tr_b16 v[42:43], v14 offset:39680
    ds_read_b128 v[28:31], v8 offset:39168
    ds_read_b64_tr_b16 v[44:45], v14 offset:39424
    ds_read_b64_tr_b16 v[46:47], v14 offset:39936
    s_waitcnt lgkmcnt(6)
    v_mfma_f32_32x32x16_bf16 v[64:79], v[48:51], v[32:35], v[64:79]
    v_mfma_f32_32x32x16_bf16 v[80:95], v[48:51], v[36:39], v[80:95]
    v_mfma_f32_32x32x16_bf16 v[96:111], v[52:55], v[32:35], v[96:111]
    v_mfma_f32_32x32x16_bf16 v[112:127], v[52:55], v[36:39], v[112:127]
    ds_read_b128 v[32:35], v9 offset:35072
    ds_read_b64_tr_b16 v[48:49], v14 offset:41216
    ds_read_b64_tr_b16 v[50:51], v14 offset:41728
    ds_read_b128 v[36:39], v9 offset:39168
    ds_read_b64_tr_b16 v[52:53], v14 offset:41472
    ds_read_b64_tr_b16 v[54:55], v14 offset:41984
    s_waitcnt lgkmcnt(6)
    v_mfma_f32_32x32x16_bf16 v[64:79], v[40:43], v[24:27], v[64:79]
    v_mfma_f32_32x32x16_bf16 v[80:95], v[40:43], v[28:31], v[80:95]
    v_mfma_f32_32x32x16_bf16 v[96:111], v[44:47], v[24:27], v[96:111]
    v_mfma_f32_32x32x16_bf16 v[112:127], v[44:47], v[28:31], v[112:127]
    s_waitcnt lgkmcnt(0)
    s_barrier
    ds_read_b128 v[24:27], v10 offset:0
    ds_read_b64_tr_b16 v[40:41], v15 offset:0
    ds_read_b64_tr_b16 v[42:43], v15 offset:512
    ds_read_b128 v[28:31], v10 offset:4096
    ds_read_b64_tr_b16 v[44:45], v15 offset:256
    ds_read_b64_tr_b16 v[46:47], v15 offset:768
    v_mfma_f32_32x32x16_bf16 v[64:79], v[48:51], v[32:35], v[64:79]
    v_mfma_f32_32x32x16_bf16 v[80:95], v[48:51], v[36:39], v[80:95]
    v_mfma_f32_32x32x16_bf16 v[96:111], v[52:55], v[32:35], v[96:111]
    v_mfma_f32_32x32x16_bf16 v[112:127], v[52:55], v[36:39], v[112:127]
    ds_read_b128 v[32:35], v11 offset:0
    ds_read_b64_tr_b16 v[48:49], v15 offset:2048
    ds_read_b64_tr_b16 v[50:51], v15 offset:2560
    ds_read_b128 v[36:39], v11 offset:4096
    ds_read_b64_tr_b16 v[52:53], v15 offset:2304
    ds_read_b64_tr_b16 v[54:55], v15 offset:2816
    s_waitcnt lgkmcnt(6)
    v_mfma_f32_32x32x16_bf16 v[64:79], v[40:43], v[24:27], v[64:79]
    v_mfma_f32_32x32x16_bf16 v[80:95], v[40:43], v[28:31], v[80:95]
    v_mfma_f32_32x32x16_bf16 v[96:111], v[44:47], v[24:27], v[96:111]
    v_mfma_f32_32x32x16_bf16 v[112:127], v[44:47], v[28:31], v[112:127]
    ds_read_b128 v[24:27], v12 offset:0
    ds_read_b64_tr_b16 v[40:41], v15 offset:4096
    ds_read_b64_tr_b16 v[42:43], v15 offset:4608
    ds_read_b128 v[28:31], v12 offset:4096
    ds_read_b64_tr_b16 v[44:45], v15 offset:4352
    ds_read_b64_tr_b16 v[46:47], v15 offset:4864
    s_waitcnt lgkmcnt(6)
    v_mfma_f32_32x32x16_bf16 v[64:79], v[48:51], v[32:35], v[64:79]
    v_mfma_f32_32x32x16_bf16 v[80:95], v[48:51], v[36:39], v[80:95]
    v_mfma_f32_32x32x16_bf16 v[96:111], v[52:55], v[32:35], v[96:111]
    v_mfma_f32_32x32x16_bf16 v[112:127], v[52:55], v[36:39], v[112:127]
    ds_read_b128 v[32:35], v13 offset:0
    ds_read_b64_tr_b16 v[48:49], v15 offset:6144
    ds_read_b64_tr_b16 v[50:51], v15 offset:6656
    ds_read_b128 v[36:39], v13 offset:4096
    ds_read_b64_tr_b16 v[52:53], v15 offset:6400
    ds_read_b64_tr_b16 v[54:55], v15 offset:6912
    s_waitcnt lgkmcnt(6)
    v_mfma_f32_32x32x16_bf16 v[64:79], v[40:43], v[24:27], v[64:79]
    v_mfma_f32_32x32x16_bf16 v[80:95], v[40:43], v[28:31], v[80:95]
    v_mfma_f32_32x32x16_bf16 v[96:111], v[44:47], v[24:27], v[96:111]
    v_mfma_f32_32x32x16_bf16 v[112:127], v[44:47], v[28:31], v[112:127]
    s_waitcnt lgkmcnt(0)
    s_barrier
    ds_read_b128 v[24:27], v10 offset:35072
    ds_read_b64_tr_b16 v[40:41], v15 offset:35072
    ds_read_b64_tr_b16 v[42:43], v15 offset:35584
    ds_read_b128 v[28:31], v10 offset:39168
    ds_read_b64_tr_b16 v[44:45], v15 offset:35328
    ds_read_b64_tr_b16 v[46:47], v15 offset:35840
    v_mfma_f32_32x32x16_bf16 v[64:79], v[48:51], v[32:35], v[64:79]
    v_mfma_f32_32x32x16_bf16 v[80:95], v[48:51], v[36:39], v[80:95]
    v_mfma_f32_32x32x16_bf16 v[96:111], v[52:55], v[32:35], v[96:111]
    v_mfma_f32_32x32x16_bf16 v[112:127], v[52:55], v[36:39], v[112:127]
    ds_read_b128 v[32:35], v11 offset:35072
    ds_read_b64_tr_b16 v[48:49], v15 offset:37120
    ds_read_b64_tr_b16 v[50:51], v15 offset:37632
    ds_read_b128 v[36:39], v11 offset:39168
    ds_read_b64_tr_b16 v[52:53], v15 offset:37376
    ds_read_b64_tr_b16 v[54:55], v15 offset:37888
    s_waitcnt lgkmcnt(6)
    v_mfma_f32_32x32x16_bf16 v[64:79], v[40:43], v[24:27], v[64:79]
    v_mfma_f32_32x32x16_bf16 v[80:95], v[40:43], v[28:31], v[80:95]
    v_mfma_f32_32x32x16_bf16 v[96:111], v[44:47], v[24:27], v[96:111]
    v_mfma_f32_32x32x16_bf16 v[112:127], v[44:47], v[28:31], v[112:127]
    ds_read_b128 v[24:27], v12 offset:35072
    ds_read_b64_tr_b16 v[40:41], v15 offset:39168
    ds_read_b64_tr_b16 v[42:43], v15 offset:39680
    ds_read_b128 v[28:31], v12 offset:39168
    ds_read_b64_tr_b16 v[44:45], v15 offset:39424
    ds_read_b64_tr_b16 v[46:47], v15 offset:39936
    s_waitcnt lgkmcnt(6)
    v_mfma_f32_32x32x16_bf16 v[64:79], v[48:51], v[32:35], v[64:79]
    v_mfma_f32_32x32x16_bf16 v[80:95], v[48:51], v[36:39], v[80:95]
    v_mfma_f32_32x32x16_bf16 v[96:111], v[52:55], v[32:35], v[96:111]
    v_mfma_f32_32x32x16_bf16 v[112:127], v[52:55], v[36:39], v[112:127]
    ds_read_b128 v[32:35], v13 offset:35072
    ds_read_b64_tr_b16 v[48:49], v15 offset:41216
    ds_read_b64_tr_b16 v[50:51], v15 offset:41728
    ds_read_b128 v[36:39], v13 offset:39168
    ds_read_b64_tr_b16 v[52:53], v15 offset:41472
    ds_read_b64_tr_b16 v[54:55], v15 offset:41984
    s_waitcnt lgkmcnt(6)
    v_mfma_f32_32x32x16_bf16 v[64:79], v[40:43], v[24:27], v[64:79]
    v_mfma_f32_32x32x16_bf16 v[80:95], v[40:43], v[28:31], v[80:95]
    v_mfma_f32_32x32x16_bf16 v[96:111], v[44:47], v[24:27], v[96:111]
    v_mfma_f32_32x32x16_bf16 v[112:127], v[44:47], v[28:31], v[112:127]
    s_waitcnt lgkmcnt(0)
    s_waitcnt vmcnt(0)
    v_cmp_eq_u32 s[66:67], s59, v128
    v_mfma_f32_32x32x16_bf16 v[64:79], v[48:51], v[32:35], v[64:79]
    v_mfma_f32_32x32x16_bf16 v[80:95], v[48:51], v[36:39], v[80:95]
    v_mfma_f32_32x32x16_bf16 v[96:111], v[52:55], v[32:35], v[96:111]
    v_mfma_f32_32x32x16_bf16 v[112:127], v[52:55], v[36:39], v[112:127]
    s_cmp_eq_u64 s[66:67], -1
    s_cbranch_scc1 PJ_md4_fast
    s_nop 7
    v_pk_mul_f32 v[64:65], v[64:65], s[54:55]
    v_pk_mul_f32 v[66:67], v[66:67], s[54:55]
    v_pk_mul_f32 v[68:69], v[68:69], s[54:55]
    v_pk_mul_f32 v[70:71], v[70:71], s[54:55]
    v_cvt_pk_bf16_f32 v24, v64, v65
    v_cvt_pk_bf16_f32 v25, v66, v67
    v_cvt_pk_bf16_f32 v26, v68, v69
    v_cvt_pk_bf16_f32 v27, v70, v71
    s_add_u32 s33, s52, 0
    buffer_store_dwordx4 v[24:27], v23, s[8:11], s33 offen sc1
    v_pk_mul_f32 v[72:73], v[72:73], s[54:55]
    v_pk_mul_f32 v[74:75], v[74:75], s[54:55]
    v_pk_mul_f32 v[76:77], v[76:77], s[54:55]
    v_pk_mul_f32 v[78:79], v[78:79], s[54:55]
    v_cvt_pk_bf16_f32 v28, v72, v73
    v_cvt_pk_bf16_f32 v29, v74, v75
    v_cvt_pk_bf16_f32 v30, v76, v77
    v_cvt_pk_bf16_f32 v31, v78, v79
    s_add_u32 s33, s52, 65536
    buffer_store_dwordx4 v[28:31], v23, s[8:11], s33 offen sc1
    v_pk_mul_f32 v[80:81], v[80:81], s[54:55]
    v_pk_mul_f32 v[82:83], v[82:83], s[54:55]
    v_pk_mul_f32 v[84:85], v[84:85], s[54:55]
    v_pk_mul_f32 v[86:87], v[86:87], s[54:55]
    v_cvt_pk_bf16_f32 v32, v80, v81
    v_cvt_pk_bf16_f32 v33, v82, v83
    v_cvt_pk_bf16_f32 v34, v84, v85
    v_cvt_pk_bf16_f32 v35, v86, v87
    s_add_u32 s33, s52, 1024
    buffer_store_dwordx4 v[32:35], v23, s[8:11], s33 offen sc1
    v_pk_mul_f32 v[88:89], v[88:89], s[54:55]
    v_pk_mul_f32 v[90:91], v[90:91], s[54:55]
    v_pk_mul_f32 v[92:93], v[92:93], s[54:55]
    v_pk_mul_f32 v[94:95], v[94:95], s[54:55]
    v_cvt_pk_bf16_f32 v36, v88, v89
    v_cvt_pk_bf16_f32 v37, v90, v91
    v_cvt_pk_bf16_f32 v38, v92, v93
    v_cvt_pk_bf16_f32 v39, v94, v95
    s_add_u32 s33, s52, 66560
    buffer_store_dwordx4 v[36:39], v23, s[8:11], s33 offen sc1
    v_pk_mul_f32 v[96:97], v[96:97], s[54:55]
    v_pk_mul_f32 v[98:99], v[98:99], s[54:55]
    v_pk_mul_f32 v[100:101], v[100:101], s[54:55]
    v_pk_mul_f32 v[102:103], v[102:103], s[54:55]
    v_cvt_pk_bf16_f32 v40, v96, v97
    v_cvt_pk_bf16_f32 v41, v98, v99
    v_cvt_pk_bf16_f32 v42, v100, v101
    v_cvt_pk_bf16_f32 v43, v102, v103
    s_add_u32 s33, s52, 131072
    buffer_store_dwordx4 v[40:43], v23, s[8:11], s33 offen sc1
    v_pk_mul_f32 v[104:105], v[104:105], s[54:55]
    v_pk_mul_f32 v[106:107], v[106:107], s[54:55]
    v_pk_mul_f32 v[108:109], v[108:109], s[54:55]
    v_pk_mul_f32 v[110:111], v[110:111], s[54:55]
    v_cvt_pk_bf16_f32 v44, v104, v105
    v_cvt_pk_bf16_f32 v45, v106, v107
    v_cvt_pk_bf16_f32 v46, v108, v109
    v_cvt_pk_bf16_f32 v47, v110, v111
    s_add_u32 s33, s52, 196608
    buffer_store_dwordx4 v[44:47], v23, s[8:11], s33 offen sc1
    v_pk_mul_f32 v[112:113], v[112:113], s[54:55]
    v_pk_mul_f32 v[114:115], v[114:115], s[54:55]
    v_pk_mul_f32 v[116:117], v[116:117], s[54:55]
    v_pk_mul_f32 v[118:119], v[118:119], s[54:55]
    v_cvt_pk_bf16_f32 v48, v112, v113
    v_cvt_pk_bf16_f32 v49, v114, v115
    v_cvt_pk_bf16_f32 v50, v116, v117
    v_cvt_pk_bf16_f32 v51, v118, v119
    s_add_u32 s33, s52, 132096
    buffer_store_dwordx4 v[48:51], v23, s[8:11], s33 offen sc1
    v_pk_mul_f32 v[120:121], v[120:121], s[54:55]
    v_pk_mul_f32 v[122:123], v[122:123], s[54:55]
    v_pk_mul_f32 v[124:125], v[124:125], s[54:55]
    v_pk_mul_f32 v[126:127], v[126:127], s[54:55]
    v_cvt_pk_bf16_f32 v52, v120, v121
    v_cvt_pk_bf16_f32 v53, v122, v123
    v_cvt_pk_bf16_f32 v54, v124, v125
    v_cvt_pk_bf16_f32 v55, v126, v127
    s_add_u32 s33, s52, 197632
    buffer_store_dwordx4 v[52:55], v23, s[8:11], s33 offen sc1
    s_branch PJ_md4_done
PJ_md4_fast:
    s_nop 7
    v_pk_mul_f32 v[64:65], v[64:65], s[54:55]
    v_pk_mul_f32 v[66:67], v[66:67], s[54:55]
    v_pk_mul_f32 v[68:69], v[68:69], s[54:55]
    v_pk_mul_f32 v[70:71], v[70:71], s[54:55]
    v_cvt_pk_bf16_f32 v24, v64, v65
    v_cvt_pk_bf16_f32 v25, v66, v67
    v_cvt_pk_bf16_f32 v26, v68, v69
    v_cvt_pk_bf16_f32 v27, v70, v71
    s_add_u32 s33, s52, 0
    buffer_store_dwordx4 v[24:27], v23, s[8:11], s33 offen
    v_pk_mul_f32 v[72:73], v[72:73], s[54:55]
    v_pk_mul_f32 v[74:75], v[74:75], s[54:55]
    v_pk_mul_f32 v[76:77], v[76:77], s[54:55]
    v_pk_mul_f32 v[78:79], v[78:79], s[54:55]
    v_cvt_pk_bf16_f32 v28, v72, v73
    v_cvt_pk_bf16_f32 v29, v74, v75
    v_cvt_pk_bf16_f32 v30, v76, v77
    v_cvt_pk_bf16_f32 v31, v78, v79
    s_add_u32 s33, s52, 65536
    buffer_store_dwordx4 v[28:31], v23, s[8:11], s33 offen
    v_pk_mul_f32 v[80:81], v[80:81], s[54:55]
    v_pk_mul_f32 v[82:83], v[82:83], s[54:55]
    v_pk_mul_f32 v[84:85], v[84:85], s[54:55]
    v_pk_mul_f32 v[86:87], v[86:87], s[54:55]
    v_cvt_pk_bf16_f32 v32, v80, v81
    v_cvt_pk_bf16_f32 v33, v82, v83
    v_cvt_pk_bf16_f32 v34, v84, v85
    v_cvt_pk_bf16_f32 v35, v86, v87
    s_add_u32 s33, s52, 1024
    buffer_store_dwordx4 v[32:35], v23, s[8:11], s33 offen
    v_pk_mul_f32 v[88:89], v[88:89], s[54:55]
    v_pk_mul_f32 v[90:91], v[90:91], s[54:55]
    v_pk_mul_f32 v[92:93], v[92:93], s[54:55]
    v_pk_mul_f32 v[94:95], v[94:95], s[54:55]
    v_cvt_pk_bf16_f32 v36, v88, v89
    v_cvt_pk_bf16_f32 v37, v90, v91
    v_cvt_pk_bf16_f32 v38, v92, v93
    v_cvt_pk_bf16_f32 v39, v94, v95
    s_add_u32 s33, s52, 66560
    buffer_store_dwordx4 v[36:39], v23, s[8:11], s33 offen
    v_pk_mul_f32 v[96:97], v[96:97], s[54:55]
    v_pk_mul_f32 v[98:99], v[98:99], s[54:55]
    v_pk_mul_f32 v[100:101], v[100:101], s[54:55]
    v_pk_mul_f32 v[102:103], v[102:103], s[54:55]
    v_cvt_pk_bf16_f32 v40, v96, v97
    v_cvt_pk_bf16_f32 v41, v98, v99
    v_cvt_pk_bf16_f32 v42, v100, v101
    v_cvt_pk_bf16_f32 v43, v102, v103
    s_add_u32 s33, s52, 131072
    buffer_store_dwordx4 v[40:43], v23, s[8:11], s33 offen
    v_pk_mul_f32 v[104:105], v[104:105], s[54:55]
    v_pk_mul_f32 v[106:107], v[106:107], s[54:55]
    v_pk_mul_f32 v[108:109], v[108:109], s[54:55]
    v_pk_mul_f32 v[110:111], v[110:111], s[54:55]
    v_cvt_pk_bf16_f32 v44, v104, v105
    v_cvt_pk_bf16_f32 v45, v106, v107
    v_cvt_pk_bf16_f32 v46, v108, v109
    v_cvt_pk_bf16_f32 v47, v110, v111
    s_add_u32 s33, s52, 196608
    buffer_store_dwordx4 v[44:47], v23, s[8:11], s33 offen
    v_pk_mul_f32 v[112:113], v[112:113], s[54:55]
    v_pk_mul_f32 v[114:115], v[114:115], s[54:55]
    v_pk_mul_f32 v[116:117], v[116:117], s[54:55]
    v_pk_mul_f32 v[118:119], v[118:119], s[54:55]
    v_cvt_pk_bf16_f32 v48, v112, v113
    v_cvt_pk_bf16_f32 v49, v114, v115
    v_cvt_pk_bf16_f32 v50, v116, v117
    v_cvt_pk_bf16_f32 v51, v118, v119
    s_add_u32 s33, s52, 132096
    buffer_store_dwordx4 v[48:51], v23, s[8:11], s33 offen
    v_pk_mul_f32 v[120:121], v[120:121], s[54:55]
    v_pk_mul_f32 v[122:123], v[122:123], s[54:55]
    v_pk_mul_f32 v[124:125], v[124:125], s[54:55]
    v_pk_mul_f32 v[126:127], v[126:127], s[54:55]
    v_cvt_pk_bf16_f32 v52, v120, v121
    v_cvt_pk_bf16_f32 v53, v122, v123
    v_cvt_pk_bf16_f32 v54, v124, v125
    v_cvt_pk_bf16_f32 v55, v126, v127
    s_add_u32 s33, s52, 197632
    buffer_store_dwordx4 v[52:55], v23, s[8:11], s33 offen
PJ_md4_done:
    s_branch PJ_end
PJ_vt:
    s_add_u32 s52, s52, 6815744
    v_bfe_u32 v16, v1, 4, 1
    v_lshlrev_b32 v16, 16, v16
    v_lshrrev_b32 v17, 5, v1
    v_lshl_add_u32 v16, v17, 8, v16
    v_and_b32 v17, 15, v1
    v_lshl_add_u32 v23, v17, 4, v16
    s_barrier
    ds_read_b128 v[24:27], v6 offset:0
    ds_read_b64_tr_b16 v[40:41], v14 offset:0
    ds_read_b64_tr_b16 v[42:43], v14 offset:512
    ds_read_b128 v[28:31], v6 offset:4096
    ds_read_b64_tr_b16 v[44:45], v14 offset:256
    ds_read_b64_tr_b16 v[46:47], v14 offset:768
    ds_read_b128 v[32:35], v7 offset:0
    ds_read_b64_tr_b16 v[48:49], v14 offset:2048
    ds_read_b64_tr_b16 v[50:51], v14 offset:2560
    ds_read_b128 v[36:39], v7 offset:4096
    ds_read_b64_tr_b16 v[52:53], v14 offset:2304
    ds_read_b64_tr_b16 v[54:55], v14 offset:2816
    s_waitcnt lgkmcnt(6)
    v_mfma_f32_32x32x16_bf16 v[64:79], v[24:27], v[40:43], v[64:79]
    v_mfma_f32_32x32x16_bf16 v[80:95], v[28:31], v[40:43], v[80:95]
    v_mfma_f32_32x32x16_bf16 v[96:111], v[24:27], v[44:47], v[96:111]
    v_mfma_f32_32x32x16_bf16 v[112:127], v[28:31], v[44:47], v[112:127]
    ds_read_b128 v[24:27], v8 offset:0
    ds_read_b64_tr_b16 v[40:41], v14 offset:4096
    ds_read_b64_tr_b16 v[42:43], v14 offset:4608
    ds_read_b128 v[28:31], v8 offset:4096
    ds_read_b64_tr_b16 v[44:45], v14 offset:4352
    ds_read_b64_tr_b16 v[46:47], v14 offset:4864
    s_waitcnt lgkmcnt(6)
    v_mfma_f32_32x32x16_bf16 v[64:79], v[32:35], v[48:51], v[64:79]
    v_mfma_f32_32x32x16_bf16 v[80:95], v[36:39], v[48:51], v[80:95]
    v_mfma_f32_32x32x16_bf16 v[96:111], v[32:35], v[52:55], v[96:111]
    v_mfma_f32_32x32x16_bf16 v[112:127], v[36:39], v[52:55], v[112:127]
    ds_read_b128 v[32:35], v9 offset:0
    ds_read_b64_tr_b16 v[48:49], v14 offset:6144
    ds_read_b64_tr_b16 v[50:51], v14 offset:6656
    ds_read_b128 v[36:39], v9 offset:4096
    ds_read_b64_tr_b16 v[52:53], v14 offset:6400
    ds_read_b64_tr_b16 v[54:55], v14 offset:6912
    s_waitcnt lgkmcnt(6)
    v_mfma_f32_32x32x16_bf16 v[64:79], v[24:27], v[40:43], v[64:79]
    v_mfma_f32_32x32x16_bf16 v[80:95], v[28:31], v[40:43], v[80:95]
    v_mfma_f32_32x32x16_bf16 v[96:111], v[24:27], v[44:47], v[96:111]
    v_mfma_f32_32x32x16_bf16 v[112:127], v[28:31], v[44:47], v[112:127]
    s_waitcnt lgkmcnt(0)
    s_barrier
    ds_read_b128 v[24:27], v6 offset:35072
    ds_read_b64_tr_b16 v[40:41], v14 offset:35072
    ds_read_b64_tr_b16 v[42:43], v14 offset:35584
    ds_read_b128 v[28:31], v6 offset:39168
    ds_read_b64_tr_b16 v[44:45], v14 offset:35328
    ds_read_b64_tr_b16 v[46:47], v14 offset:35840
    v_mfma_f32_32x32x16_bf16 v[64:79], v[32:35], v[48:51], v[64:79]
    v_mfma_f32_32x32x16_bf16 v[80:95], v[36:39], v[48:51], v[80:95]
    v_mfma_f32_32x32x16_bf16 v[96:111], v[32:35], v[52:55], v[96:111]
    v_mfma_f32_32x32x16_bf16 v[112:127], v[36:39], v[52:55], v[112:127]
    s_waitcnt vmcnt(0)
    v_readfirstlane_b32 s12, v22
    s_nop 1
    s_add_u32 s59, s59, 1
    s_add_u32 s12, s12, 0x9e3779b9
    s_add_u32 s59, s59, s12
    s_cmp_lg_u32 s3, 0
    s_cbranch_scc1 PJ_v_noxt
    s_lshl_b32 s32, s29, 7
    s_lshr_b32 s33, s2, 3
    s_lshl_b32 s33, s33, 2
    s_add_u32 s32, s32, s33
    s_add_u32 s32, s32, 13647872
    v_mov_b32 v16, s32
    v_mov_b32 v17, s59
    s_mov_b64 exec, 1
    buffer_store_dword v17, v16, s[8:11], 0 offen sc1
    s_mov_b64 exec, -1
PJ_v_noxt:
    ds_read_b128 v[32:35], v7 offset:35072
    ds_read_b64_tr_b16 v[48:49], v14 offset:37120
    ds_read_b64_tr_b16 v[50:51], v14 offset:37632
    ds_read_b128 v[36:39], v7 offset:39168
    ds_read_b64_tr_b16 v[52:53], v14 offset:37376
    ds_read_b64_tr_b16 v[54:55], v14 offset:37888
    s_waitcnt lgkmcnt(6)
    v_mfma_f32_32x32x16_bf16 v[64:79], v[24:27], v[40:43], v[64:79]
    v_mfma_f32_32x32x16_bf16 v[80:95], v[28:31], v[40:43], v[80:95]
    v_mfma_f32_32x32x16_bf16 v[96:111], v[24:27], v[44:47], v[96:111]
    v_mfma_f32_32x32x16_bf16 v[112:127], v[28:31], v[44:47], v[112:127]
    ds_read_b128 v[24:27], v8 offset:35072
    ds_read_b64_tr_b16 v[40:41], v14 offset:39168
    ds_read_b64_tr_b16 v[42:43], v14 offset:39680
    ds_read_b128 v[28:31], v8 offset:39168
    ds_read_b64_tr_b16 v[44:45], v14 offset:39424
    ds_read_b64_tr_b16 v[46:47], v14 offset:39936
    s_waitcnt lgkmcnt(6)
    v_mfma_f32_32x32x16_bf16 v[64:79], v[32:35], v[48:51], v[64:79]
    v_mfma_f32_32x32x16_bf16 v[80:95], v[36:39], v[48:51], v[80:95]
    v_mfma_f32_32x32x16_bf16 v[96:111], v[32:35], v[52:55], v[96:111]
    v_mfma_f32_32x32x16_bf16 v[112:127], v[36:39], v[52:55], v[112:127]
    ds_read_b128 v[32:35], v9 offset:35072
    ds_read_b64_tr_b16 v[48:49], v14 offset:41216
    ds_read_b64_tr_b16 v[50:51], v14 offset:41728
    ds_read_b128 v[36:39], v9 offset:39168
    ds_read_b64_tr_b16 v[52:53], v14 offset:41472
    ds_read_b64_tr_b16 v[54:55], v14 offset:41984
    s_waitcnt lgkmcnt(6)
    v_mfma_f32_32x32x16_bf16 v[64:79], v[24:27], v[40:43], v[64:79]
    v_mfma_f32_32x32x16_bf16 v[80:95], v[28:31], v[40:43], v[80:95]
    v_mfma_f32_32x32x16_bf16 v[96:111], v[24:27], v[44:47], v[96:111]
    v_mfma_f32_32x32x16_bf16 v[112:127], v[28:31], v[44:47], v[112:127]
    s_waitcnt lgkmcnt(0)
    s_barrier
    ds_read_b128 v[24:27], v10 offset:0
    ds_read_b64_tr_b16 v[40:41], v15 offset:0
    ds_read_b64_tr_b16 v[42:43], v15 offset:512
    ds_read_b128 v[28:31], v10 offset:4096
    ds_read_b64_tr_b16 v[44:45], v15 offset:256
    ds_read_b64_tr_b16 v[46:47], v15 offset:768
    v_mfma_f32_32x32x16_bf16 v[64:79], v[32:35], v[48:51], v[64:79]
    v_mfma_f32_32x32x16_bf16 v[80:95], v[36:39], v[48:51], v[80:95]
    v_mfma_f32_32x32x16_bf16 v[96:111], v[32:35], v[52:55], v[96:111]
    v_mfma_f32_32x32x16_bf16 v[112:127], v[36:39], v[52:55], v[112:127]
    ds_read_b128 v[32:35], v11 offset:0
    ds_read_b64_tr_b16 v[48:49], v15 offset:2048
    ds_read_b64_tr_b16 v[50:51], v15 offset:2560
    ds_read_b128 v[36:39], v11 offset:4096
    ds_read_b64_tr_b16 v[52:53], v15 offset:2304
    ds_read_b64_tr_b16 v[54:55], v15 offset:2816
    s_waitcnt lgkmcnt(6)
    v_mfma_f32_32x32x16_bf16 v[64:79], v[24:27], v[40:43], v[64:79]
    v_mfma_f32_32x32x16_bf16 v[80:95], v[28:31], v[40:43], v[80:95]
    v_mfma_f32_32x32x16_bf16 v[96:111], v[24:27], v[44:47], v[96:111]
    v_mfma_f32_32x32x16_bf16 v[112:127], v[28:31], v[44:47], v[112:127]
    ds_read_b128 v[24:27], v12 offset:0
    ds_read_b64_tr_b16 v[40:41], v15 offset:4096
    ds_read_b64_tr_b16 v[42:43], v15 offset:4608
    ds_read_b128 v[28:31], v12 offset:4096
    ds_read_b64_tr_b16 v[44:45], v15 offset:4352
    ds_read_b64_tr_b16 v[46:47], v15 offset:4864
    s_waitcnt lgkmcnt(6)
    v_mfma_f32_32x32x16_bf16 v[64:79], v[32:35], v[48:51], v[64:79]
    v_mfma_f32_32x32x16_bf16 v[80:95], v[36:39], v[48:51], v[80:95]
    v_mfma_f32_32x32x16_bf16 v[96:111], v[32:35], v[52:55], v[96:111]
    v_mfma_f32_32x32x16_bf16 v[112:127], v[36:39], v[52:55], v[112:127]
    ds_read_b128 v[32:35], v13 offset:0
    ds_read_b64_tr_b16 v[48:49], v15 offset:6144
    ds_read_b64_tr_b16 v[50:51], v15 offset:6656
    ds_read_b128 v[36:39], v13 offset:4096
    ds_read_b64_tr_b16 v[52:53], v15 offset:6400
    ds_read_b64_tr_b16 v[54:55], v15 offset:6912
    s_waitcnt lgkmcnt(6)
    v_mfma_f32_32x32x16_bf16 v[64:79], v[24:27], v[40:43], v[64:79]
    v_mfma_f32_32x32x16_bf16 v[80:95], v[28:31], v[40:43], v[80:95]
    v_mfma_f32_32x32x16_bf16 v[96:111], v[24:27], v[44:47], v[96:111]
    v_mfma_f32_32x32x16_bf16 v[112:127], v[28:31], v[44:47], v[112:127]
    s_waitcnt lgkmcnt(0)
    s_barrier
    ds_read_b128 v[24:27], v10 offset:35072
    ds_read_b64_tr_b16 v[40:41], v15 offset:35072
    ds_read_b64_tr_b16 v[42:43], v15 offset:35584
    ds_read_b128 v[28:31], v10 offset:39168
    ds_read_b64_tr_b16 v[44:45], v15 offset:35328
    ds_read_b64_tr_b16 v[46:47], v15 offset:35840
    v_mfma_f32_32x32x16_bf16 v[64:79], v[32:35], v[48:51], v[64:79]
    v_mfma_f32_32x32x16_bf16 v[80:95], v[36:39], v[48:51], v[80:95]
    v_mfma_f32_32x32x16_bf16 v[96:111], v[32:35], v[52:55], v[96:111]
    v_mfma_f32_32x32x16_bf16 v[112:127], v[36:39], v[52:55], v[112:127]
    ds_read_b128 v[32:35], v11 offset:35072
    ds_read_b64_tr_b16 v[48:49], v15 offset:37120
    ds_read_b64_tr_b16 v[50:51], v15 offset:37632
    ds_read_b128 v[36:39], v11 offset:39168
    ds_read_b64_tr_b16 v[52:53], v15 offset:37376
    ds_read_b64_tr_b16 v[54:55], v15 offset:37888
    s_waitcnt lgkmcnt(6)
    v_mfma_f32_32x32x16_bf16 v[64:79], v[24:27], v[40:43], v[64:79]
    v_mfma_f32_32x32x16_bf16 v[80:95], v[28:31], v[40:43], v[80:95]
    v_mfma_f32_32x32x16_bf16 v[96:111], v[24:27], v[44:47], v[96:111]
    v_mfma_f32_32x32x16_bf16 v[112:127], v[28:31], v[44:47], v[112:127]
    ds_read_b128 v[24:27], v12 offset:35072
    ds_read_b64_tr_b16 v[40:41], v15 offset:39168
    ds_read_b64_tr_b16 v[42:43], v15 offset:39680
    ds_read_b128 v[28:31], v12 offset:39168
    ds_read_b64_tr_b16 v[44:45], v15 offset:39424
    ds_read_b64_tr_b16 v[46:47], v15 offset:39936
    s_waitcnt lgkmcnt(6)
    v_mfma_f32_32x32x16_bf16 v[64:79], v[32:35], v[48:51], v[64:79]
    v_mfma_f32_32x32x16_bf16 v[80:95], v[36:39], v[48:51], v[80:95]
    v_mfma_f32_32x32x16_bf16 v[96:111], v[32:35], v[52:55], v[96:111]
    v_mfma_f32_32x32x16_bf16 v[112:127], v[36:39], v[52:55], v[112:127]
    ds_read_b128 v[32:35], v13 offset:35072
    ds_read_b64_tr_b16 v[48:49], v15 offset:41216
    ds_read_b64_tr_b16 v[50:51], v15 offset:41728
    ds_read_b128 v[36:39], v13 offset:39168
    ds_read_b64_tr_b16 v[52:53], v15 offset:41472
    ds_read_b64_tr_b16 v[54:55], v15 offset:41984
    s_waitcnt lgkmcnt(6)
    v_mfma_f32_32x32x16_bf16 v[64:79], v[24:27], v[40:43], v[64:79]
    v_mfma_f32_32x32x16_bf16 v[80:95], v[28:31], v[40:43], v[80:95]
    v_mfma_f32_32x32x16_bf16 v[96:111], v[24:27], v[44:47], v[96:111]
    v_mfma_f32_32x32x16_bf16 v[112:127], v[28:31], v[44:47], v[112:127]
    s_waitcnt lgkmcnt(0)
    s_barrier
    ds_read_b128 v[24:27], v6 offset:0
    ds_read_b64_tr_b16 v[40:41], v14 offset:0
    ds_read_b64_tr_b16 v[42:43], v14 offset:512
    ds_read_b128 v[28:31], v6 offset:4096
    ds_read_b64_tr_b16 v[44:45], v14 offset:256
    ds_read_b64_tr_b16 v[46:47], v14 offset:768
    v_mfma_f32_32x32x16_bf16 v[64:79], v[32:35], v[48:51], v[64:79]
    v_mfma_f32_32x32x16_bf16 v[80:95], v[36:39], v[48:51], v[80:95]
    v_mfma_f32_32x32x16_bf16 v[96:111], v[32:35], v[52:55], v[96:111]
    v_mfma_f32_32x32x16_bf16 v[112:127], v[36:39], v[52:55], v[112:127]
    ds_read_b128 v[32:35], v7 offset:0
    ds_read_b64_tr_b16 v[48:49], v14 offset:2048
    ds_read_b64_tr_b16 v[50:51], v14 offset:2560
    ds_read_b128 v[36:39], v7 offset:4096
    ds_read_b64_tr_b16 v[52:53], v14 offset:2304
    ds_read_b64_tr_b16 v[54:55], v14 offset:2816
    s_waitcnt lgkmcnt(6)
    v_mfma_f32_32x32x16_bf16 v[64:79], v[24:27], v[40:43], v[64:79]
    v_mfma_f32_32x32x16_bf16 v[80:95], v[28:31], v[40:43], v[80:95]
    v_mfma_f32_32x32x16_bf16 v[96:111], v[24:27], v[44:47], v[96:111]
    v_mfma_f32_32x32x16_bf16 v[112:127], v[28:31], v[44:47], v[112:127]
    ds_read_b128 v[24:27], v8 offset:0
    ds_read_b64_tr_b16 v[40:41], v14 offset:4096
    ds_read_b64_tr_b16 v[42:43], v14 offset:4608
    ds_read_b128 v[28:31], v8 offset:4096
    ds_read_b64_tr_b16 v[44:45], v14 offset:4352
    ds_read_b64_tr_b16 v[46:47], v14 offset:4864
    s_waitcnt lgkmcnt(6)
    v_mfma_f32_32x32x16_bf16 v[64:79], v[32:35], v[48:51], v[64:79]
    v_mfma_f32_32x32x16_bf16 v[80:95], v[36:39], v[48:51], v[80:95]
    v_mfma_f32_32x32x16_bf16 v[96:111], v[32:35], v[52:55], v[96:111]
    v_mfma_f32_32x32x16_bf16 v[112:127], v[36:39], v[52:55], v[112:127]
    ds_read_b128 v[32:35], v9 offset:0
    ds_read_b64_tr_b16 v[48:49], v14 offset:6144
    ds_read_b64_tr_b16 v[50:51], v14 offset:6656
    ds_read_b128 v[36:39], v9 offset:4096
    ds_read_b64_tr_b16 v[52:53], v14 offset:6400
    ds_read_b64_tr_b16 v[54:55], v14 offset:6912
    s_waitcnt lgkmcnt(6)
    v_mfma_f32_32x32x16_bf16 v[64:79], v[24:27], v[40:43], v[64:79]
    v_mfma_f32_32x32x16_bf16 v[80:95], v[28:31], v[40:43], v[80:95]
    v_mfma_f32_32x32x16_bf16 v[96:111], v[24:27], v[44:47], v[96:111]
    v_mfma_f32_32x32x16_bf16 v[112:127], v[28:31], v[44:47], v[112:127]
    s_waitcnt lgkmcnt(0)
    s_barrier
    ds_read_b128 v[24:27], v6 offset:35072
    ds_read_b64_tr_b16 v[40:41], v14 offset:35072
    ds_read_b64_tr_b16 v[42:43], v14 offset:35584
    ds_read_b128 v[28:31], v6 offset:39168
    ds_read_b64_tr_b16 v[44:45], v14 offset:35328
    ds_read_b64_tr_b16 v[46:47], v14 offset:35840
    v_mfma_f32_32x32x16_bf16 v[64:79], v[32:35], v[48:51], v[64:79]
    v_mfma_f32_32x32x16_bf16 v[80:95], v[36:39], v[48:51], v[80:95]
    v_mfma_f32_32x32x16_bf16 v[96:111], v[32:35], v[52:55], v[96:111]
    v_mfma_f32_32x32x16_bf16 v[112:127], v[36:39], v[52:55], v[112:127]
    v_and_b32 v16, 31, v1
    v_lshlrev_b32 v16, 2, v16
    s_lshl_b32 s32, s29, 7
    s_add_u32 s32, s32, 13647872
    buffer_load_dword v128, v16, s[8:11], s32 offen sc1
    ds_read_b128 v[32:35], v7 offset:35072
    ds_read_b64_tr_b16 v[48:49], v14 offset:37120
    ds_read_b64_tr_b16 v[50:51], v14 offset:37632
    ds_read_b128 v[36:39], v7 offset:39168
    ds_read_b64_tr_b16 v[52:53], v14 offset:37376
    ds_read_b64_tr_b16 v[54:55], v14 offset:37888
    s_waitcnt lgkmcnt(6)
    v_mfma_f32_32x32x16_bf16 v[64:79], v[24:27], v[40:43], v[64:79]
    v_mfma_f32_32x32x16_bf16 v[80:95], v[28:31], v[40:43], v[80:95]
    v_mfma_f32_32x32x16_bf16 v[96:111], v[24:27], v[44:47], v[96:111]
    v_mfma_f32_32x32x16_bf16 v[112:127], v[28:31], v[44:47], v[112:127]
    ds_read_b128 v[24:27], v8 offset:35072
    ds_read_b64_tr_b16 v[40:41], v14 offset:39168
    ds_read_b64_tr_b16 v[42:43], v14 offset:39680
    ds_read_b128 v[28:31], v8 offset:39168
    ds_read_b64_tr_b16 v[44:45], v14 offset:39424
    ds_read_b64_tr_b16 v[46:47], v14 offset:39936
    s_waitcnt lgkmcnt(6)
    v_mfma_f32_32x32x16_bf16 v[64:79], v[32:35], v[48:51], v[64:79]
    v_mfma_f32_32x32x16_bf16 v[80:95], v[36:39], v[48:51], v[80:95]
    v_mfma_f32_32x32x16_bf16 v[96:111], v[32:35], v[52:55], v[96:111]
    v_mfma_f32_32x32x16_bf16 v[112:127], v[36:39], v[52:55], v[112:127]
    ds_read_b128 v[32:35], v9 offset:35072
    ds_read_b64_tr_b16 v[48:49], v14 offset:41216
    ds_read_b64_tr_b16 v[50:51], v14 offset:41728
    ds_read_b128 v[36:39], v9 offset:39168
    ds_read_b64_tr_b16 v[52:53], v14 offset:41472
    ds_read_b64_tr_b16 v[54:55], v14 offset:41984
    s_waitcnt lgkmcnt(6)
    v_mfma_f32_32x32x16_bf16 v[64:79], v[24:27], v[40:43], v[64:79]
    v_mfma_f32_32x32x16_bf16 v[80:95], v[28:31], v[40:43], v[80:95]
    v_mfma_f32_32x32x16_bf16 v[96:111], v[24:27], v[44:47], v[96:111]
    v_mfma_f32_32x32x16_bf16 v[112:127], v[28:31], v[44:47], v[112:127]
    s_waitcnt lgkmcnt(0)
    s_barrier
    ds_read_b128 v[24:27], v10 offset:0
    ds_read_b64_tr_b16 v[40:41], v15 offset:0
    ds_read_b64_tr_b16 v[42:43], v15 offset:512
    ds_read_b128 v[28:31], v10 offset:4096
    ds_read_b64_tr_b16 v[44:45], v15 offset:256
    ds_read_b64_tr_b16 v[46:47], v15 offset:768
    v_mfma_f32_32x32x16_bf16 v[64:79], v[32:35], v[48:51], v[64:79]
    v_mfma_f32_32x32x16_bf16 v[80:95], v[36:39], v[48:51], v[80:95]
    v_mfma_f32_32x32x16_bf16 v[96:111], v[32:35], v[52:55], v[96:111]
    v_mfma_f32_32x32x16_bf16 v[112:127], v[36:39], v[52:55], v[112:127]
    ds_read_b128 v[32:35], v11 offset:0
    ds_read_b64_tr_b16 v[48:49], v15 offset:2048
    ds_read_b64_tr_b16 v[50:51], v15 offset:2560
    ds_read_b128 v[36:39], v11 offset:4096
    ds_read_b64_tr_b16 v[52:53], v15 offset:2304
    ds_read_b64_tr_b16 v[54:55], v15 offset:2816
    s_waitcnt lgkmcnt(6)
    v_mfma_f32_32x32x16_bf16 v[64:79], v[24:27], v[40:43], v[64:79]
    v_mfma_f32_32x32x16_bf16 v[80:95], v[28:31], v[40:43], v[80:95]
    v_mfma_f32_32x32x16_bf16 v[96:111], v[24:27], v[44:47], v[96:111]
    v_mfma_f32_32x32x16_bf16 v[112:127], v[28:31], v[44:47], v[112:127]
    ds_read_b128 v[24:27], v12 offset:0
    ds_read_b64_tr_b16 v[40:41], v15 offset:4096
    ds_read_b64_tr_b16 v[42:43], v15 offset:4608
    ds_read_b128 v[28:31], v12 offset:4096
    ds_read_b64_tr_b16 v[44:45], v15 offset:4352
    ds_read_b64_tr_b16 v[46:47], v15 offset:4864
    s_waitcnt lgkmcnt(6)
    v_mfma_f32_32x32x16_bf16 v[64:79], v[32:35], v[48:51], v[64:79]
    v_mfma_f32_32x32x16_bf16 v[80:95], v[36:39], v[48:51], v[80:95]
    v_mfma_f32_32x32x16_bf16 v[96:111], v[32:35], v[52:55], v[96:111]
    v_mfma_f32_32x32x16_bf16 v[112:127], v[36:39], v[52:55], v[112:127]
    ds_read_b128 v[32:35], v13 offset:0
    ds_read_b64_tr_b16 v[48:49], v15 offset:6144
    ds_read_b64_tr_b16 v[50:51], v15 offset:6656
    ds_read_b128 v[36:39], v13 offset:4096
    ds_read_b64_tr_b16 v[52:53], v15 offset:6400
    ds_read_b64_tr_b16 v[54:55], v15 offset:6912
    s_waitcnt lgkmcnt(6)
    v_mfma_f32_32x32x16_bf16 v[64:79], v[24:27], v[40:43], v[64:79]
    v_mfma_f32_32x32x16_bf16 v[80:95], v[28:31], v[40:43], v[80:95]
    v_mfma_f32_32x32x16_bf16 v[96:111], v[24:27], v[44:47], v[96:111]
    v_mfma_f32_32x32x16_bf16 v[112:127], v[28:31], v[44:47], v[112:127]
    s_waitcnt lgkmcnt(0)
    s_barrier
    ds_read_b128 v[24:27], v10 offset:35072
    ds_read_b64_tr_b16 v[40:41], v15 offset:35072
    ds_read_b64_tr_b16 v[42:43], v15 offset:35584
    ds_read_b128 v[28:31], v10 offset:39168
    ds_read_b64_tr_b16 v[44:45], v15 offset:35328
    ds_read_b64_tr_b16 v[46:47], v15 offset:35840
    v_mfma_f32_32x32x16_bf16 v[64:79], v[32:35], v[48:51], v[64:79]
    v_mfma_f32_32x32x16_bf16 v[80:95], v[36:39], v[48:51], v[80:95]
    v_mfma_f32_32x32x16_bf16 v[96:111], v[32:35], v[52:55], v[96:111]
    v_mfma_f32_32x32x16_bf16 v[112:127], v[36:39], v[52:55], v[112:127]
    ds_read_b128 v[32:35], v11 offset:35072
    ds_read_b64_tr_b16 v[48:49], v15 offset:37120
    ds_read_b64_tr_b16 v[50:51], v15 offset:37632
    ds_read_b128 v[36:39], v11 offset:39168
    ds_read_b64_tr_b16 v[52:53], v15 offset:37376
    ds_read_b64_tr_b16 v[54:55], v15 offset:37888
    s_waitcnt lgkmcnt(6)
    v_mfma_f32_32x32x16_bf16 v[64:79], v[24:27], v[40:43], v[64:79]
    v_mfma_f32_32x32x16_bf16 v[80:95], v[28:31], v[40:43], v[80:95]
    v_mfma_f32_32x32x16_bf16 v[96:111], v[24:27], v[44:47], v[96:111]
    v_mfma_f32_32x32x16_bf16 v[112:127], v[28:31], v[44:47], v[112:127]
    ds_read_b128 v[24:27], v12 offset:35072
    ds_read_b64_tr_b16 v[40:41], v15 offset:39168
    ds_read_b64_tr_b16 v[42:43], v15 offset:39680
    ds_read_b128 v[28:31], v12 offset:39168
    ds_read_b64_tr_b16 v[44:45], v15 offset:39424
    ds_read_b64_tr_b16 v[46:47], v15 offset:39936
    s_waitcnt lgkmcnt(6)
    v_mfma_f32_32x32x16_bf16 v[64:79], v[32:35], v[48:51], v[64:79]
    v_mfma_f32_32x32x16_bf16 v[80:95], v[36:39], v[48:51], v[80:95]
    v_mfma_f32_32x32x16_bf16 v[96:111], v[32:35], v[52:55], v[96:111]
    v_mfma_f32_32x32x16_bf16 v[112:127], v[36:39], v[52:55], v[112:127]
    ds_read_b128 v[32:35], v13 offset:35072
    ds_read_b64_tr_b16 v[48:49], v15 offset:41216
    ds_read_b64_tr_b16 v[50:51], v15 offset:41728
    ds_read_b128 v[36:39], v13 offset:39168
    ds_read_b64_tr_b16 v[52:53], v15 offset:41472
    ds_read_b64_tr_b16 v[54:55], v15 offset:41984
    s_waitcnt lgkmcnt(6)
    v_mfma_f32_32x32x16_bf16 v[64:79], v[24:27], v[40:43], v[64:79]
    v_mfma_f32_32x32x16_bf16 v[80:95], v[28:31], v[40:43], v[80:95]
    v_mfma_f32_32x32x16_bf16 v[96:111], v[24:27], v[44:47], v[96:111]
    v_mfma_f32_32x32x16_bf16 v[112:127], v[28:31], v[44:47], v[112:127]
    s_waitcnt lgkmcnt(0)
    s_waitcnt vmcnt(0)
    v_cmp_eq_u32 s[66:67], s59, v128
    v_mfma_f32_32x32x16_bf16 v[64:79], v[32:35], v[48:51], v[64:79]
    v_mfma_f32_32x32x16_bf16 v[80:95], v[36:39], v[48:51], v[80:95]
    v_mfma_f32_32x32x16_bf16 v[96:111], v[32:35], v[52:55], v[96:111]
    v_mfma_f32_32x32x16_bf16 v[112:127], v[36:39], v[52:55], v[112:127]
    s_cmp_eq_u64 s[66:67], -1
    s_cbranch_scc1 PJ_md5_fast
    s_nop 7
    v_cvt_pk_bf16_f32 v24, v64, v65
    v_cvt_pk_bf16_f32 v25, v66, v67
    v_cvt_pk_bf16_f32 v26, v68, v69
    v_cvt_pk_bf16_f32 v27, v70, v71
    s_add_u32 s33, s52, 0
    buffer_store_dwordx4 v[24:27], v23, s[8:11], s33 offen sc1
    v_cvt_pk_bf16_f32 v28, v72, v73
    v_cvt_pk_bf16_f32 v29, v74, v75
    v_cvt_pk_bf16_f32 v30, v76, v77
    v_cvt_pk_bf16_f32 v31, v78, v79
    s_add_u32 s33, s52, 512
    buffer_store_dwordx4 v[28:31], v23, s[8:11], s33 offen sc1
    v_cvt_pk_bf16_f32 v32, v80, v81
    v_cvt_pk_bf16_f32 v33, v82, v83
    v_cvt_pk_bf16_f32 v34, v84, v85
    v_cvt_pk_bf16_f32 v35, v86, v87
    s_add_u32 s33, s52, 1024
    buffer_store_dwordx4 v[32:35], v23, s[8:11], s33 offen sc1
    v_cvt_pk_bf16_f32 v36, v88, v89
    v_cvt_pk_bf16_f32 v37, v90, v91
    v_cvt_pk_bf16_f32 v38, v92, v93
    v_cvt_pk_bf16_f32 v39, v94, v95
    s_add_u32 s33, s52, 1536
    buffer_store_dwordx4 v[36:39], v23, s[8:11], s33 offen sc1
    v_cvt_pk_bf16_f32 v40, v96, v97
    v_cvt_pk_bf16_f32 v41, v98, v99
    v_cvt_pk_bf16_f32 v42, v100, v101
    v_cvt_pk_bf16_f32 v43, v102, v103
    s_add_u32 s33, s52, 131072
    buffer_store_dwordx4 v[40:43], v23, s[8:11], s33 offen sc1
    v_cvt_pk_bf16_f32 v44, v104, v105
    v_cvt_pk_bf16_f32 v45, v106, v107
    v_cvt_pk_bf16_f32 v46, v108, v109
    v_cvt_pk_bf16_f32 v47, v110, v111
    s_add_u32 s33, s52, 131584
    buffer_store_dwordx4 v[44:47], v23, s[8:11], s33 offen sc1
    v_cvt_pk_bf16_f32 v48, v112, v113
    v_cvt_pk_bf16_f32 v49, v114, v115
    v_cvt_pk_bf16_f32 v50, v116, v117
    v_cvt_pk_bf16_f32 v51, v118, v119
    s_add_u32 s33, s52, 132096
    buffer_store_dwordx4 v[48:51], v23, s[8:11], s33 offen sc1
    v_cvt_pk_bf16_f32 v52, v120, v121
    v_cvt_pk_bf16_f32 v53, v122, v123
    v_cvt_pk_bf16_f32 v54, v124, v125
    v_cvt_pk_bf16_f32 v55, v126, v127
    s_add_u32 s33, s52, 132608
    buffer_store_dwordx4 v[52:55], v23, s[8:11], s33 offen sc1
    s_branch PJ_md5_done
PJ_md5_fast:
    s_nop 7
    v_cvt_pk_bf16_f32 v24, v64, v65
    v_cvt_pk_bf16_f32 v25, v66, v67
    v_cvt_pk_bf16_f32 v26, v68, v69
    v_cvt_pk_bf16_f32 v27, v70, v71
    s_add_u32 s33, s52, 0
    buffer_store_dwordx4 v[24:27], v23, s[8:11], s33 offen
    v_cvt_pk_bf16_f32 v28, v72, v73
    v_cvt_pk_bf16_f32 v29, v74, v75
    v_cvt_pk_bf16_f32 v30, v76, v77
    v_cvt_pk_bf16_f32 v31, v78, v79
    s_add_u32 s33, s52, 512
    buffer_store_dwordx4 v[28:31], v23, s[8:11], s33 offen
    v_cvt_pk_bf16_f32 v32, v80, v81
    v_cvt_pk_bf16_f32 v33, v82, v83
    v_cvt_pk_bf16_f32 v34, v84, v85
    v_cvt_pk_bf16_f32 v35, v86, v87
    s_add_u32 s33, s52, 1024
    buffer_store_dwordx4 v[32:35], v23, s[8:11], s33 offen
    v_cvt_pk_bf16_f32 v36, v88, v89
    v_cvt_pk_bf16_f32 v37, v90, v91
    v_cvt_pk_bf16_f32 v38, v92, v93
    v_cvt_pk_bf16_f32 v39, v94, v95
    s_add_u32 s33, s52, 1536
    buffer_store_dwordx4 v[36:39], v23, s[8:11], s33 offen
    v_cvt_pk_bf16_f32 v40, v96, v97
    v_cvt_pk_bf16_f32 v41, v98, v99
    v_cvt_pk_bf16_f32 v42, v100, v101
    v_cvt_pk_bf16_f32 v43, v102, v103
    s_add_u32 s33, s52, 131072
    buffer_store_dwordx4 v[40:43], v23, s[8:11], s33 offen
    v_cvt_pk_bf16_f32 v44, v104, v105
    v_cvt_pk_bf16_f32 v45, v106, v107
    v_cvt_pk_bf16_f32 v46, v108, v109
    v_cvt_pk_bf16_f32 v47, v110, v111
    s_add_u32 s33, s52, 131584
    buffer_store_dwordx4 v[44:47], v23, s[8:11], s33 offen
    v_cvt_pk_bf16_f32 v48, v112, v113
    v_cvt_pk_bf16_f32 v49, v114, v115
    v_cvt_pk_bf16_f32 v50, v116, v117
    v_cvt_pk_bf16_f32 v51, v118, v119
    s_add_u32 s33, s52, 132096
    buffer_store_dwordx4 v[48:51], v23, s[8:11], s33 offen
    v_cvt_pk_bf16_f32 v52, v120, v121
    v_cvt_pk_bf16_f32 v53, v122, v123
    v_cvt_pk_bf16_f32 v54, v124, v125
    v_cvt_pk_bf16_f32 v55, v126, v127
    s_add_u32 s33, s52, 132608
    buffer_store_dwordx4 v[52:55], v23, s[8:11], s33 offen
PJ_md5_done:
PJ_end:
    s_waitcnt vmcnt(0)
    s_barrier
    s_cmp_lg_u32 s3, 0
    s_cbranch_scc1 PJ_noflag
    s_lshl_b32 s32, s29, 7
    s_lshr_b32 s33, s2, 3
    s_lshl_b32 s33, s33, 2
    s_add_u32 s32, s32, s33
    s_add_u32 s32, s32, 13631488
    v_mov_b32 v16, s32
    v_mov_b32 v17, s12
    s_mov_b64 exec, 1
    s_cmp_eq_u64 s[66:67], -1
    s_cbranch_scc1 PJ_md6_fast
    buffer_store_dword v17, v16, s[8:11], 0 offen sc1
    s_branch PJ_md6_done
PJ_md6_fast:
    buffer_store_dword v17, v16, s[8:11], 0 offen
PJ_md6_done:
    s_mov_b64 exec, -1
PJ_noflag:
    v_mbcnt_lo_u32_b32 v1, -1, 0
    v_mbcnt_hi_u32_b32 v1, -1, v1
    s_and_b32 s30, s2, 7
    s_lshr_b32 s31, s2, 3
    s_and_b32 s21, s31, 3
    s_lshr_b32 s31, s31, 2
    s_lshl_b32 s30, s30, 2
    s_and_b32 s20, s31, 3
    s_add_u32 s20, s20, s30
    s_and_b32 s15, s2, 7
    s_add_u32 s15, s15, 32
    s_cmp_ge_u32 s31, 4
    s_cselect_b32 s22, s15, s20
    s_cselect_b32 s30, 32, 0
    s_add_u32 s20, s20, s30
    s_cmp_lg_u32 s3, 0
    s_cbranch_scc1 AT_nopoll
    s_and_b32 s15, s2, 7
    s_lshl_b32 s15, s15, 7
    v_and_b32 v130, 31, v1
    v_lshlrev_b32 v131, 2, v130
    s_add_u32 s16, s15, 13631488
    v_add_u32 v131, s16, v131
    s_mov_b32 s14, 131072
AT_poll:
    buffer_load_dword v132, v131, s[8:11], 0 offen sc1
    s_waitcnt vmcnt(0)
    v_cmp_eq_u32 vcc, s12, v132
    s_nop 1
    s_cmp_eq_u64 vcc, -1
    s_cbranch_scc1 AT_poll_ok
    s_sleep 2
    s_sub_u32 s14, s14, 1
    s_cmp_lg_u32 s14, 0
    s_cbranch_scc1 AT_poll
AT_poll_ok:
AT_nopoll:
    v_and_b32 v131, 31, v1
    v_lshrrev_b32 v132, 5, v1
    v_lshlrev_b32 v127, 4, v1
    v_lshlrev_b32 v128, 4, v131
    v_lshl_add_u32 v128, v132, 8, v128
    v_add_u32 v129, 512, v128
    v_mov_b32 v133, 1024
    v_cmp_eq_u32 vcc, 16, v131
    s_nop 1
    v_cndmask_b32 v128, v128, v133, vcc
    v_cndmask_b32 v129, v129, v133, vcc
    v_mov_b32 v133, 0x30000
    v_cmp_lt_u32 vcc, 16, v131
    s_nop 1
    v_cndmask_b32 v128, v128, v133, vcc
    v_cndmask_b32 v129, v129, v133, vcc
    v_add_u32 v128, 65536, v128
    v_add_u32 v129, 65536, v129
    v_mov_b32 v1, v127
    s_lshl_b32 s27, s20, 16
    s_lshl_b32 s30, s21, 4
    s_mul_i32 s31, s3, 2
    s_add_u32 s30, s30, s31
    s_lshl_b32 s31, s30, 10
    s_add_u32 s27, s27, s31
    s_add_u32 s32, s27, 9437184
    s_lshl_b32 s30, s22, 16
    s_lshl_b32 s31, s3, 10
    s_add_u32 s23, s30, s31
    s_add_u32 s25, s23, 6815744
    s_add_u32 s23, s23, 4194304
    s_mov_b32 s24, s31
    s_mul_i32 s26, s3, 1040
    s_add_u32 s26, s26, 65536
    s_cmp_lg_u32 s3, 1
    s_cbranch_scc1 AT_noones
    v_lshrrev_b32 v130, 4, v1
    v_mul_u32_u24 v130, 1040, v130
    v_add_u32 v130, 66560, v130
    v_mov_b32 v74, 0x3f803f80
    v_mov_b32 v75, 0x3f803f80
    v_mov_b32 v76, 0x3f803f80
    v_mov_b32 v77, 0x3f803f80
    ds_write_b128 v130, v[74:77]
AT_noones:
    v_mov_b32 v126, 0xdddddddd
    s_mov_b32 s29, 0
    v_mov_b32 v42, 0
    v_mov_b32 v43, 0
    v_mov_b32 v44, 0
    v_mov_b32 v45, 0
    v_mov_b32 v46, 0
    v_mov_b32 v47, 0
    v_mov_b32 v48, 0
    v_mov_b32 v49, 0
    v_mov_b32 v50, 0
    v_mov_b32 v51, 0
    v_mov_b32 v52, 0
    v_mov_b32 v53, 0
    v_mov_b32 v54, 0
    v_mov_b32 v55, 0
    v_mov_b32 v56, 0
    v_mov_b32 v57, 0
    v_mov_b32 v58, 0
    v_mov_b32 v59, 0
    v_mov_b32 v60, 0
    v_mov_b32 v61, 0
    v_mov_b32 v62, 0
    v_mov_b32 v63, 0
    v_mov_b32 v64, 0
    v_mov_b32 v65, 0
    v_mov_b32 v66, 0
    v_mov_b32 v67, 0
    v_mov_b32 v68, 0
    v_mov_b32 v69, 0
    v_mov_b32 v70, 0
    v_mov_b32 v71, 0
    v_mov_b32 v72, 0
    v_mov_b32 v73, 0
    s_barrier
    buffer_load_dwordx4 v[2:5], v1, s[8:11], s27 offen sc1
    s_add_u32 s31, s27, 1024
    buffer_load_dwordx4 v[6:9], v1, s[8:11], s31 offen sc1
    s_mov_b32 m0, s24
    s_add_u32 s24, s24, 8192
    buffer_load_dwordx4 v1, s[8:11], s23 offen sc1 lds
    s_add_u32 s23, s23, 8192
    s_mov_b32 m0, s26
    s_add_u32 s26, s26, 8320
    buffer_load_dwordx4 v1, s[8:11], s25 offen sc1 lds
    s_add_u32 s25, s25, 8192
    s_waitcnt vmcnt(0) lgkmcnt(0)
    s_barrier
    s_cmp_lt_u32 s3, 4
    s_cbranch_scc1 AT_nodma
    s_sub_u32 s23, s23, 4096
    s_sub_u32 s25, s25, 4096
    s_sub_u32 s24, s24, 4096
    s_sub_u32 s26, s26, 4160
    s_mov_b32 m0, s24
    s_add_u32 s24, s24, 4096
    buffer_load_dwordx4 v1, s[8:11], s23 offen sc1 lds
    s_add_u32 s23, s23, 4096
    s_mov_b32 m0, s26
    s_add_u32 s26, s26, 4160
    buffer_load_dwordx4 v1, s[8:11], s25 offen sc1 lds
    s_add_u32 s25, s25, 4096
    s_mov_b32 m0, s24
    s_add_u32 s24, s24, 4096
    buffer_load_dwordx4 v1, s[8:11], s23 offen sc1 lds
    s_add_u32 s23, s23, 4096
    s_mov_b32 m0, s26
    s_add_u32 s26, s26, 4160
    buffer_load_dwordx4 v1, s[8:11], s25 offen sc1 lds
    s_add_u32 s25, s25, 4096
    s_mov_b32 m0, s24
    s_add_u32 s24, s24, 4096
    buffer_load_dwordx4 v1, s[8:11], s23 offen sc1 lds
    s_add_u32 s23, s23, 4096
    s_mov_b32 m0, s26
    s_add_u32 s26, s26, 4160
    buffer_load_dwordx4 v1, s[8:11], s25 offen sc1 lds
    s_add_u32 s25, s25, 4096
    s_mov_b32 m0, s24
    s_add_u32 s24, s24, 4096
    buffer_load_dwordx4 v1, s[8:11], s23 offen sc1 lds
    s_add_u32 s23, s23, 4096
    s_mov_b32 m0, s26
    s_add_u32 s26, s26, 4160
    buffer_load_dwordx4 v1, s[8:11], s25 offen sc1 lds
    s_add_u32 s25, s25, 4096
    s_mov_b32 m0, s24
    s_add_u32 s24, s24, 4096
    buffer_load_dwordx4 v1, s[8:11], s23 offen sc1 lds
    s_add_u32 s23, s23, 4096
    s_mov_b32 m0, s26
    s_add_u32 s26, s26, 4160
    buffer_load_dwordx4 v1, s[8:11], s25 offen sc1 lds
    s_add_u32 s25, s25, 4096
    s_mov_b32 m0, s24
    s_add_u32 s24, s24, 4096
    buffer_load_dwordx4 v1, s[8:11], s23 offen sc1 lds
    s_add_u32 s23, s23, 4096
    s_mov_b32 m0, s26
    s_add_u32 s26, s26, 4160
    buffer_load_dwordx4 v1, s[8:11], s25 offen sc1 lds
    s_add_u32 s25, s25, 4096
    s_mov_b32 m0, s24
    s_add_u32 s24, s24, 4096
    buffer_load_dwordx4 v1, s[8:11], s23 offen sc1 lds
    s_add_u32 s23, s23, 4096
    s_mov_b32 m0, s26
    s_add_u32 s26, s26, 4160
    buffer_load_dwordx4 v1, s[8:11], s25 offen sc1 lds
    s_add_u32 s25, s25, 4096
    s_mov_b32 m0, s24
    s_add_u32 s24, s24, 4096
    buffer_load_dwordx4 v1, s[8:11], s23 offen sc1 lds
    s_add_u32 s23, s23, 4096
    s_mov_b32 m0, s26
    s_add_u32 s26, s26, 4160
    buffer_load_dwordx4 v1, s[8:11], s25 offen sc1 lds
    s_add_u32 s25, s25, 4096
    s_mov_b32 m0, s24
    s_add_u32 s24, s24, 4096
    buffer_load_dwordx4 v1, s[8:11], s23 offen sc1 lds
    s_add_u32 s23, s23, 4096
    s_mov_b32 m0, s26
    s_add_u32 s26, s26, 4160
    buffer_load_dwordx4 v1, s[8:11], s25 offen sc1 lds
    s_add_u32 s25, s25, 4096
    s_mov_b32 m0, s24
    s_add_u32 s24, s24, 4096
    buffer_load_dwordx4 v1, s[8:11], s23 offen sc1 lds
    s_add_u32 s23, s23, 4096
    s_mov_b32 m0, s26
    s_add_u32 s26, s26, 4160
    buffer_load_dwordx4 v1, s[8:11], s25 offen sc1 lds
    s_add_u32 s25, s25, 4096
    s_mov_b32 m0, s24
    s_add_u32 s24, s24, 4096
    buffer_load_dwordx4 v1, s[8:11], s23 offen sc1 lds
    s_add_u32 s23, s23, 4096
    s_mov_b32 m0, s26
    s_add_u32 s26, s26, 4160
    buffer_load_dwordx4 v1, s[8:11], s25 offen sc1 lds
    s_add_u32 s25, s25, 4096
    s_mov_b32 m0, s24
    s_add_u32 s24, s24, 4096
    buffer_load_dwordx4 v1, s[8:11], s23 offen sc1 lds
    s_add_u32 s23, s23, 4096
    s_mov_b32 m0, s26
    s_add_u32 s26, s26, 4160
    buffer_load_dwordx4 v1, s[8:11], s25 offen sc1 lds
    s_add_u32 s25, s25, 4096
    s_mov_b32 m0, s24
    s_add_u32 s24, s24, 4096
    buffer_load_dwordx4 v1, s[8:11], s23 offen sc1 lds
    s_add_u32 s23, s23, 4096
    s_mov_b32 m0, s26
    s_add_u32 s26, s26, 4160
    buffer_load_dwordx4 v1, s[8:11], s25 offen sc1 lds
    s_add_u32 s25, s25, 4096
    s_mov_b32 m0, s24
    s_add_u32 s24, s24, 4096
    buffer_load_dwordx4 v1, s[8:11], s23 offen sc1 lds
    s_add_u32 s23, s23, 4096
    s_mov_b32 m0, s26
    s_add_u32 s26, s26, 4160
    buffer_load_dwordx4 v1, s[8:11], s25 offen sc1 lds
    s_add_u32 s25, s25, 4096
    s_waitcnt vmcnt(0)
    s_barrier
    s_mov_b32 s33, 0
    s_branch AT_sy
AT_nodma:
    s_mov_b32 s33, 1
AT_sy:
    ds_read_b128 v[106:109], v127 offset:0
    s_waitcnt lgkmcnt(0)
    v_mfma_f32_32x32x16_bf16 v[74:89], v[106:109], v[2:5], 0
    v_mfma_f32_32x32x16_bf16 v[90:105], v[106:109], v[6:9], 0
    s_nop 7
    s_nop 3
    v_max3_f32 v130, v74, v75, v76
    v_max3_f32 v131, v77, v78, v79
    v_max3_f32 v130, v130, v80, v81
    v_max3_f32 v131, v131, v82, v83
    v_max3_f32 v130, v130, v84, v85
    v_max3_f32 v131, v131, v86, v87
    v_max3_f32 v130, v130, v88, v89
    v_max_f32 v130, v130, v131
    v_max3_f32 v132, v90, v91, v92
    v_max3_f32 v133, v93, v94, v95
    v_max3_f32 v132, v132, v96, v97
    v_max3_f32 v133, v133, v98, v99
    v_max3_f32 v132, v132, v100, v101
    v_max3_f32 v133, v133, v102, v103
    v_max3_f32 v132, v132, v104, v105
    v_max_f32 v132, v132, v133
    v_mov_b32 v131, v130
    v_mov_b32 v133, v132
    s_nop 1
    v_permlane32_swap_b32 v130, v131
    v_permlane32_swap_b32 v132, v133
    s_nop 1
    v_max_f32 v130, v130, v131
    v_add_f32 v130, 0x42cc0000, v130
    v_sub_f32 v10, 0, v130
    v_mov_b32 v11, v10
    v_mov_b32 v12, v10
    v_mov_b32 v13, v10
    v_mov_b32 v14, v10
    v_mov_b32 v15, v10
    v_mov_b32 v16, v10
    v_mov_b32 v17, v10
    v_mov_b32 v18, v10
    v_mov_b32 v19, v10
    v_mov_b32 v20, v10
    v_mov_b32 v21, v10
    v_mov_b32 v22, v10
    v_mov_b32 v23, v10
    v_mov_b32 v24, v10
    v_mov_b32 v25, v10
    v_max_f32 v132, v132, v133
    v_add_f32 v132, 0x42cc0000, v132
    v_sub_f32 v26, 0, v132
    v_mov_b32 v27, v26
    v_mov_b32 v28, v26
    v_mov_b32 v29, v26
    v_mov_b32 v30, v26
    v_mov_b32 v31, v26
    v_mov_b32 v32, v26
    v_mov_b32 v33, v26
    v_mov_b32 v34, v26
    v_mov_b32 v35, v26
    v_mov_b32 v36, v26
    v_mov_b32 v37, v26
    v_mov_b32 v38, v26
    v_mov_b32 v39, v26
    v_mov_b32 v40, v26
    v_mov_b32 v41, v26
AT_run:
    ds_read_b128 v[106:109], v127
    ds_read_b128 v[110:113], v128
    ds_read_b128 v[118:121], v129
    v_mov_b32 v98, 0
    v_mov_b32 v99, 0
    v_mov_b32 v100, 0
    v_mov_b32 v101, 0
    v_mov_b32 v102, 0
    v_mov_b32 v103, 0
    v_mov_b32 v104, 0
    v_mov_b32 v105, 0
    v_mov_b32 v122, 0
    v_mov_b32 v123, 0
    v_mov_b32 v124, 0
    v_mov_b32 v125, 0
    s_waitcnt lgkmcnt(0)
    v_mfma_f32_32x32x16_bf16 v[74:89], v[106:109], v[2:5], v[10:25]
    s_mov_b32 s28, 0
    s_cmp_ge_u32 s3, 4
    s_cbranch_scc1 AT_p1
    s_setprio 2
    s_branch AT_p2
AT_p1:
    s_setprio 1
AT_p2:
    s_nop 7
    s_nop 3
    .p2align 3
AT_loop:
    v_exp_f32 v74, v74
    v_exp_f32 v75, v75
    v_smfmac_f32_32x32x32_bf16 v[58:73], v[122:125], v[98:105], v126
    v_exp_f32 v76, v76
    v_exp_f32 v77, v77
    v_exp_f32 v78, v78
    v_mfma_f32_32x32x16_bf16 v[90:105], v[106:109], v[6:9], v[26:41]
    ds_read_b128 v[106:109], v127 offset:1024
    ds_read_b128 v[114:117], v128 offset:1040
    ds_read_b128 v[122:125], v129 offset:1040
    v_exp_f32 v79, v79
    v_exp_f32 v80, v80
    v_exp_f32 v81, v81
    v_exp_f32 v82, v82
    v_exp_f32 v83, v83
    v_smfmac_f32_32x32x32_bf16 v[42:57], v[110:113], v[74:81], v126
    v_exp_f32 v84, v84
    v_exp_f32 v85, v85
    v_exp_f32 v86, v86
    v_exp_f32 v87, v87
    v_exp_f32 v88, v88
    v_exp_f32 v89, v89
    v_exp_f32 v90, v90
    v_exp_f32 v91, v91
    v_smfmac_f32_32x32x32_bf16 v[42:57], v[118:121], v[82:89], v126
    v_exp_f32 v92, v92
    v_exp_f32 v93, v93
    v_exp_f32 v94, v94
    s_waitcnt lgkmcnt(0)
    v_mfma_f32_32x32x16_bf16 v[74:89], v[106:109], v[2:5], v[10:25]
    v_exp_f32 v95, v95
    v_exp_f32 v96, v96
    v_exp_f32 v97, v97
    v_exp_f32 v98, v98
    v_exp_f32 v99, v99
    v_smfmac_f32_32x32x32_bf16 v[58:73], v[110:113], v[90:97], v126
    v_exp_f32 v100, v100
    v_exp_f32 v101, v101
    v_exp_f32 v102, v102
    v_exp_f32 v103, v103
    v_exp_f32 v104, v104
    v_exp_f32 v105, v105
    v_exp_f32 v74, v74
    v_exp_f32 v75, v75
    v_smfmac_f32_32x32x32_bf16 v[58:73], v[118:121], v[98:105], v126
    v_exp_f32 v76, v76
    v_exp_f32 v77, v77
    v_exp_f32 v78, v78
    v_mfma_f32_32x32x16_bf16 v[90:105], v[106:109], v[6:9], v[26:41]
    ds_read_b128 v[106:109], v127 offset:2048
    ds_read_b128 v[110:113], v128 offset:2080
    ds_read_b128 v[118:121], v129 offset:2080
    v_exp_f32 v79, v79
    v_exp_f32 v80, v80
    v_exp_f32 v81, v81
    v_exp_f32 v82, v82
    v_exp_f32 v83, v83
    v_smfmac_f32_32x32x32_bf16 v[42:57], v[114:117], v[74:81], v126
    v_exp_f32 v84, v84
    v_exp_f32 v85, v85
    v_exp_f32 v86, v86
    v_exp_f32 v87, v87
    v_exp_f32 v88, v88
    v_exp_f32 v89, v89
    v_exp_f32 v90, v90
    v_exp_f32 v91, v91
    v_smfmac_f32_32x32x32_bf16 v[42:57], v[122:125], v[82:89], v126
    v_exp_f32 v92, v92
    v_exp_f32 v93, v93
    v_exp_f32 v94, v94
    s_waitcnt lgkmcnt(0)
    v_mfma_f32_32x32x16_bf16 v[74:89], v[106:109], v[2:5], v[10:25]
    v_exp_f32 v95, v95
    v_exp_f32 v96, v96
    v_exp_f32 v97, v97
    v_exp_f32 v98, v98
    v_exp_f32 v99, v99
    v_smfmac_f32_32x32x32_bf16 v[58:73], v[114:117], v[90:97], v126
    v_exp_f32 v100, v100
    v_exp_f32 v101, v101
    v_exp_f32 v102, v102
    v_exp_f32 v103, v103
    v_exp_f32 v104, v104
    v_exp_f32 v105, v105
    v_exp_f32 v74, v74
    v_exp_f32 v75, v75
    v_smfmac_f32_32x32x32_bf16 v[58:73], v[122:125], v[98:105], v126
    v_exp_f32 v76, v76
    v_exp_f32 v77, v77
    v_exp_f32 v78, v78
    v_mfma_f32_32x32x16_bf16 v[90:105], v[106:109], v[6:9], v[26:41]
    ds_read_b128 v[106:109], v127 offset:3072
    ds_read_b128 v[114:117], v128 offset:3120
    ds_read_b128 v[122:125], v129 offset:3120
    v_exp_f32 v79, v79
    v_exp_f32 v80, v80
    v_exp_f32 v81, v81
    v_exp_f32 v82, v82
    v_exp_f32 v83, v83
    v_smfmac_f32_32x32x32_bf16 v[42:57], v[110:113], v[74:81], v126
    v_exp_f32 v84, v84
    v_exp_f32 v85, v85
    v_exp_f32 v86, v86
    v_exp_f32 v87, v87
    v_exp_f32 v88, v88
    v_exp_f32 v89, v89
    v_exp_f32 v90, v90
    v_exp_f32 v91, v91
    v_smfmac_f32_32x32x32_bf16 v[42:57], v[118:121], v[82:89], v126
    v_exp_f32 v92, v92
    v_exp_f32 v93, v93
    v_exp_f32 v94, v94
    s_waitcnt lgkmcnt(0)
    v_mfma_f32_32x32x16_bf16 v[74:89], v[106:109], v[2:5], v[10:25]
    v_exp_f32 v95, v95
    v_exp_f32 v96, v96
    v_exp_f32 v97, v97
    v_exp_f32 v98, v98
    v_exp_f32 v99, v99
    v_smfmac_f32_32x32x32_bf16 v[58:73], v[110:113], v[90:97], v126
    v_exp_f32 v100, v100
    v_exp_f32 v101, v101
    v_exp_f32 v102, v102
    v_exp_f32 v103, v103
    v_exp_f32 v104, v104
    v_exp_f32 v105, v105
    v_exp_f32 v74, v74
    v_exp_f32 v75, v75
    v_smfmac_f32_32x32x32_bf16 v[58:73], v[118:121], v[98:105], v126
    v_exp_f32 v76, v76
    v_exp_f32 v77, v77
    v_exp_f32 v78, v78
    v_mfma_f32_32x32x16_bf16 v[90:105], v[106:109], v[6:9], v[26:41]
    ds_read_b128 v[106:109], v127 offset:4096
    ds_read_b128 v[110:113], v128 offset:4160
    ds_read_b128 v[118:121], v129 offset:4160
    v_exp_f32 v79, v79
    v_exp_f32 v80, v80
    v_exp_f32 v81, v81
    v_exp_f32 v82, v82
    v_exp_f32 v83, v83
    v_smfmac_f32_32x32x32_bf16 v[42:57], v[114:117], v[74:81], v126
    v_exp_f32 v84, v84
    v_exp_f32 v85, v85
    v_exp_f32 v86, v86
    v_exp_f32 v87, v87
    v_exp_f32 v88, v88
    v_exp_f32 v89, v89
    v_exp_f32 v90, v90
    v_exp_f32 v91, v91
    v_smfmac_f32_32x32x32_bf16 v[42:57], v[122:125], v[82:89], v126
    v_exp_f32 v92, v92
    v_exp_f32 v93, v93
    v_exp_f32 v94, v94
    s_waitcnt lgkmcnt(0)
    v_mfma_f32_32x32x16_bf16 v[74:89], v[106:109], v[2:5], v[10:25]
    v_exp_f32 v95, v95
    v_exp_f32 v96, v96
    v_exp_f32 v97, v97
    v_exp_f32 v98, v98
    v_exp_f32 v99, v99
    v_smfmac_f32_32x32x32_bf16 v[58:73], v[114:117], v[90:97], v126
    v_exp_f32 v100, v100
    v_exp_f32 v101, v101
    v_exp_f32 v102, v102
    v_exp_f32 v103, v103
    v_exp_f32 v104, v104
    v_exp_f32 v105, v105
    v_exp_f32 v74, v74
    v_exp_f32 v75, v75
    v_smfmac_f32_32x32x32_bf16 v[58:73], v[122:125], v[98:105], v126
    v_exp_f32 v76, v76
    v_exp_f32 v77, v77
    v_exp_f32 v78, v78
    v_mfma_f32_32x32x16_bf16 v[90:105], v[106:109], v[6:9], v[26:41]
    ds_read_b128 v[106:109], v127 offset:5120
    ds_read_b128 v[114:117], v128 offset:5200
    ds_read_b128 v[122:125], v129 offset:5200
    v_exp_f32 v79, v79
    v_exp_f32 v80, v80
    v_exp_f32 v81, v81
    v_exp_f32 v82, v82
    v_exp_f32 v83, v83
    v_smfmac_f32_32x32x32_bf16 v[42:57], v[110:113], v[74:81], v126
    v_exp_f32 v84, v84
    v_exp_f32 v85, v85
    v_exp_f32 v86, v86
    v_exp_f32 v87, v87
    v_exp_f32 v88, v88
    v_exp_f32 v89, v89
    v_exp_f32 v90, v90
    v_exp_f32 v91, v91
    v_smfmac_f32_32x32x32_bf16 v[42:57], v[118:121], v[82:89], v126
    v_exp_f32 v92, v92
    v_exp_f32 v93, v93
    v_exp_f32 v94, v94
    s_waitcnt lgkmcnt(0)
    v_mfma_f32_32x32x16_bf16 v[74:89], v[106:109], v[2:5], v[10:25]
    v_exp_f32 v95, v95
    v_exp_f32 v96, v96
    v_exp_f32 v97, v97
    v_exp_f32 v98, v98
    v_exp_f32 v99, v99
    v_smfmac_f32_32x32x32_bf16 v[58:73], v[110:113], v[90:97], v126
    v_exp_f32 v100, v100
    v_exp_f32 v101, v101
    v_exp_f32 v102, v102
    v_exp_f32 v103, v103
    v_exp_f32 v104, v104
    v_exp_f32 v105, v105
    v_exp_f32 v74, v74
    v_exp_f32 v75, v75
    v_smfmac_f32_32x32x32_bf16 v[58:73], v[118:121], v[98:105], v126
    v_exp_f32 v76, v76
    v_exp_f32 v77, v77
    v_exp_f32 v78, v78
    v_mfma_f32_32x32x16_bf16 v[90:105], v[106:109], v[6:9], v[26:41]
    ds_read_b128 v[106:109], v127 offset:6144
    ds_read_b128 v[110:113], v128 offset:6240
    ds_read_b128 v[118:121], v129 offset:6240
    v_exp_f32 v79, v79
    v_exp_f32 v80, v80
    v_exp_f32 v81, v81
    v_exp_f32 v82, v82
    v_exp_f32 v83, v83
    v_smfmac_f32_32x32x32_bf16 v[42:57], v[114:117], v[74:81], v126
    v_exp_f32 v84, v84
    v_exp_f32 v85, v85
    v_exp_f32 v86, v86
    v_exp_f32 v87, v87
    v_exp_f32 v88, v88
    v_exp_f32 v89, v89
    v_exp_f32 v90, v90
    v_exp_f32 v91, v91
    v_smfmac_f32_32x32x32_bf16 v[42:57], v[122:125], v[82:89], v126
    v_exp_f32 v92, v92
    v_exp_f32 v93, v93
    v_exp_f32 v94, v94
    s_waitcnt lgkmcnt(0)
    v_mfma_f32_32x32x16_bf16 v[74:89], v[106:109], v[2:5], v[10:25]
    v_exp_f32 v95, v95
    v_exp_f32 v96, v96
    v_exp_f32 v97, v97
    v_exp_f32 v98, v98
    v_exp_f32 v99, v99
    v_smfmac_f32_32x32x32_bf16 v[58:73], v[114:117], v[90:97], v126
    v_exp_f32 v100, v100
    v_exp_f32 v101, v101
    v_exp_f32 v102, v102
    v_exp_f32 v103, v103
    v_exp_f32 v104, v104
    v_exp_f32 v105, v105
    v_exp_f32 v74, v74
    v_exp_f32 v75, v75
    v_smfmac_f32_32x32x32_bf16 v[58:73], v[122:125], v[98:105], v126
    v_exp_f32 v76, v76
    v_exp_f32 v77, v77
    v_exp_f32 v78, v78
    v_mfma_f32_32x32x16_bf16 v[90:105], v[106:109], v[6:9], v[26:41]
    ds_read_b128 v[106:109], v127 offset:7168
    ds_read_b128 v[114:117], v128 offset:7280
    ds_read_b128 v[122:125], v129 offset:7280
    v_exp_f32 v79, v79
    v_exp_f32 v80, v80
    v_exp_f32 v81, v81
    v_exp_f32 v82, v82
    v_exp_f32 v83, v83
    v_smfmac_f32_32x32x32_bf16 v[42:57], v[110:113], v[74:81], v126
    v_exp_f32 v84, v84
    v_exp_f32 v85, v85
    v_exp_f32 v86, v86
    v_exp_f32 v87, v87
    v_exp_f32 v88, v88
    v_exp_f32 v89, v89
    v_exp_f32 v90, v90
    v_exp_f32 v91, v91
    v_smfmac_f32_32x32x32_bf16 v[42:57], v[118:121], v[82:89], v126
    v_exp_f32 v92, v92
    v_exp_f32 v93, v93
    v_exp_f32 v94, v94
    s_waitcnt lgkmcnt(0)
    v_mfma_f32_32x32x16_bf16 v[74:89], v[106:109], v[2:5], v[10:25]
    v_exp_f32 v95, v95
    v_exp_f32 v96, v96
    v_exp_f32 v97, v97
    v_exp_f32 v98, v98
    v_exp_f32 v99, v99
    v_smfmac_f32_32x32x32_bf16 v[58:73], v[110:113], v[90:97], v126
    v_exp_f32 v100, v100
    v_exp_f32 v101, v101
    v_exp_f32 v102, v102
    v_exp_f32 v103, v103
    v_exp_f32 v104, v104
    v_exp_f32 v105, v105
    v_exp_f32 v74, v74
    v_exp_f32 v75, v75
    v_smfmac_f32_32x32x32_bf16 v[58:73], v[118:121], v[98:105], v126
    v_exp_f32 v76, v76
    v_exp_f32 v77, v77
    v_exp_f32 v78, v78
    v_mfma_f32_32x32x16_bf16 v[90:105], v[106:109], v[6:9], v[26:41]
    s_cmp_eq_u32 s33, 0
    s_cbranch_scc1 AT_synced
    s_waitcnt vmcnt(0)
    s_barrier
    s_mov_b32 s33, 0
AT_synced:
    ds_read_b128 v[106:109], v127 offset:8192
    ds_read_b128 v[110:113], v128 offset:8320
    ds_read_b128 v[118:121], v129 offset:8320
    v_exp_f32 v79, v79
    v_exp_f32 v80, v80
    v_exp_f32 v81, v81
    v_exp_f32 v82, v82
    v_exp_f32 v83, v83
    v_smfmac_f32_32x32x32_bf16 v[42:57], v[114:117], v[74:81], v126
    v_exp_f32 v84, v84
    v_exp_f32 v85, v85
    v_exp_f32 v86, v86
    v_exp_f32 v87, v87
    v_exp_f32 v88, v88
    v_exp_f32 v89, v89
    v_exp_f32 v90, v90
    v_exp_f32 v91, v91
    v_smfmac_f32_32x32x32_bf16 v[42:57], v[122:125], v[82:89], v126
    v_exp_f32 v92, v92
    v_exp_f32 v93, v93
    v_exp_f32 v94, v94
    s_waitcnt lgkmcnt(0)
    v_mfma_f32_32x32x16_bf16 v[74:89], v[106:109], v[2:5], v[10:25]
    v_exp_f32 v95, v95
    v_exp_f32 v96, v96
    v_exp_f32 v97, v97
    v_exp_f32 v98, v98
    v_exp_f32 v99, v99
    v_smfmac_f32_32x32x32_bf16 v[58:73], v[114:117], v[90:97], v126
    v_exp_f32 v100, v100
    v_exp_f32 v101, v101
    v_exp_f32 v102, v102
    v_exp_f32 v103, v103
    v_exp_f32 v104, v104
    v_exp_f32 v105, v105
    v_exp_f32 v74, v74
    v_exp_f32 v75, v75
    v_smfmac_f32_32x32x32_bf16 v[58:73], v[122:125], v[98:105], v126
    v_exp_f32 v76, v76
    v_exp_f32 v77, v77
    v_exp_f32 v78, v78
    v_mfma_f32_32x32x16_bf16 v[90:105], v[106:109], v[6:9], v[26:41]
    ds_read_b128 v[106:109], v127 offset:9216
    ds_read_b128 v[114:117], v128 offset:9360
    ds_read_b128 v[122:125], v129 offset:9360
    v_exp_f32 v79, v79
    v_exp_f32 v80, v80
    v_exp_f32 v81, v81
    v_exp_f32 v82, v82
    v_exp_f32 v83, v83
    v_smfmac_f32_32x32x32_bf16 v[42:57], v[110:113], v[74:81], v126
    v_exp_f32 v84, v84
    v_exp_f32 v85, v85
    v_exp_f32 v86, v86
    v_exp_f32 v87, v87
    v_exp_f32 v88, v88
    v_exp_f32 v89, v89
    v_exp_f32 v90, v90
    v_exp_f32 v91, v91
    v_smfmac_f32_32x32x32_bf16 v[42:57], v[118:121], v[82:89], v126
    v_exp_f32 v92, v92
    v_exp_f32 v93, v93
    v_exp_f32 v94, v94
    s_waitcnt lgkmcnt(0)
    v_mfma_f32_32x32x16_bf16 v[74:89], v[106:109], v[2:5], v[10:25]
    v_exp_f32 v95, v95
    v_exp_f32 v96, v96
    v_exp_f32 v97, v97
    v_exp_f32 v98, v98
    v_exp_f32 v99, v99
    v_smfmac_f32_32x32x32_bf16 v[58:73], v[110:113], v[90:97], v126
    v_exp_f32 v100, v100
    v_exp_f32 v101, v101
    v_exp_f32 v102, v102
    v_exp_f32 v103, v103
    v_exp_f32 v104, v104
    v_exp_f32 v105, v105
    v_exp_f32 v74, v74
    v_exp_f32 v75, v75
    v_smfmac_f32_32x32x32_bf16 v[58:73], v[118:121], v[98:105], v126
    v_exp_f32 v76, v76
    v_exp_f32 v77, v77
    v_exp_f32 v78, v78
    v_mfma_f32_32x32x16_bf16 v[90:105], v[106:109], v[6:9], v[26:41]
    ds_read_b128 v[106:109], v127 offset:10240
    ds_read_b128 v[110:113], v128 offset:10400
    ds_read_b128 v[118:121], v129 offset:10400
    v_exp_f32 v79, v79
    v_exp_f32 v80, v80
    v_exp_f32 v81, v81
    v_exp_f32 v82, v82
    v_exp_f32 v83, v83
    v_smfmac_f32_32x32x32_bf16 v[42:57], v[114:117], v[74:81], v126
    v_exp_f32 v84, v84
    v_exp_f32 v85, v85
    v_exp_f32 v86, v86
    v_exp_f32 v87, v87
    v_exp_f32 v88, v88
    v_exp_f32 v89, v89
    v_exp_f32 v90, v90
    v_exp_f32 v91, v91
    v_smfmac_f32_32x32x32_bf16 v[42:57], v[122:125], v[82:89], v126
    v_exp_f32 v92, v92
    v_exp_f32 v93, v93
    v_exp_f32 v94, v94
    s_waitcnt lgkmcnt(0)
    v_mfma_f32_32x32x16_bf16 v[74:89], v[106:109], v[2:5], v[10:25]
    v_exp_f32 v95, v95
    v_exp_f32 v96, v96
    v_exp_f32 v97, v97
    v_exp_f32 v98, v98
    v_exp_f32 v99, v99
    v_smfmac_f32_32x32x32_bf16 v[58:73], v[114:117], v[90:97], v126
    v_exp_f32 v100, v100
    v_exp_f32 v101, v101
    v_exp_f32 v102, v102
    v_exp_f32 v103, v103
    v_exp_f32 v104, v104
    v_exp_f32 v105, v105
    v_exp_f32 v74, v74
    v_exp_f32 v75, v75
    v_smfmac_f32_32x32x32_bf16 v[58:73], v[122:125], v[98:105], v126
    v_exp_f32 v76, v76
    v_exp_f32 v77, v77
    v_exp_f32 v78, v78
    v_mfma_f32_32x32x16_bf16 v[90:105], v[106:109], v[6:9], v[26:41]
    ds_read_b128 v[106:109], v127 offset:11264
    ds_read_b128 v[114:117], v128 offset:11440
    ds_read_b128 v[122:125], v129 offset:11440
    v_exp_f32 v79, v79
    v_exp_f32 v80, v80
    v_exp_f32 v81, v81
    v_exp_f32 v82, v82
    v_exp_f32 v83, v83
    v_smfmac_f32_32x32x32_bf16 v[42:57], v[110:113], v[74:81], v126
    v_exp_f32 v84, v84
    v_exp_f32 v85, v85
    v_exp_f32 v86, v86
    v_exp_f32 v87, v87
    v_exp_f32 v88, v88
    v_exp_f32 v89, v89
    v_exp_f32 v90, v90
    v_exp_f32 v91, v91
    v_smfmac_f32_32x32x32_bf16 v[42:57], v[118:121], v[82:89], v126
    v_exp_f32 v92, v92
    v_exp_f32 v93, v93
    v_exp_f32 v94, v94
    s_waitcnt lgkmcnt(0)
    v_mfma_f32_32x32x16_bf16 v[74:89], v[106:109], v[2:5], v[10:25]
    v_exp_f32 v95, v95
    v_exp_f32 v96, v96
    v_exp_f32 v97, v97
    v_exp_f32 v98, v98
    v_exp_f32 v99, v99
    v_smfmac_f32_32x32x32_bf16 v[58:73], v[110:113], v[90:97], v126
    v_exp_f32 v100, v100
    v_exp_f32 v101, v101
    v_exp_f32 v102, v102
    v_exp_f32 v103, v103
    v_exp_f32 v104, v104
    v_exp_f32 v105, v105
    v_exp_f32 v74, v74
    v_exp_f32 v75, v75
    v_smfmac_f32_32x32x32_bf16 v[58:73], v[118:121], v[98:105], v126
    v_exp_f32 v76, v76
    v_exp_f32 v77, v77
    v_exp_f32 v78, v78
    v_mfma_f32_32x32x16_bf16 v[90:105], v[106:109], v[6:9], v[26:41]
    ds_read_b128 v[106:109], v127 offset:12288
    ds_read_b128 v[110:113], v128 offset:12480
    ds_read_b128 v[118:121], v129 offset:12480
    v_exp_f32 v79, v79
    v_exp_f32 v80, v80
    v_exp_f32 v81, v81
    v_exp_f32 v82, v82
    v_exp_f32 v83, v83
    v_smfmac_f32_32x32x32_bf16 v[42:57], v[114:117], v[74:81], v126
    v_exp_f32 v84, v84
    v_exp_f32 v85, v85
    v_exp_f32 v86, v86
    v_exp_f32 v87, v87
    v_exp_f32 v88, v88
    v_exp_f32 v89, v89
    v_exp_f32 v90, v90
    v_exp_f32 v91, v91
    v_smfmac_f32_32x32x32_bf16 v[42:57], v[122:125], v[82:89], v126
    v_exp_f32 v92, v92
    v_exp_f32 v93, v93
    v_exp_f32 v94, v94
    s_waitcnt lgkmcnt(0)
    v_mfma_f32_32x32x16_bf16 v[74:89], v[106:109], v[2:5], v[10:25]
    v_exp_f32 v95, v95
    v_exp_f32 v96, v96
    v_exp_f32 v97, v97
    v_exp_f32 v98, v98
    v_exp_f32 v99, v99
    v_smfmac_f32_32x32x32_bf16 v[58:73], v[114:117], v[90:97], v126
    v_exp_f32 v100, v100
    v_exp_f32 v101, v101
    v_exp_f32 v102, v102
    v_exp_f32 v103, v103
    v_exp_f32 v104, v104
    v_exp_f32 v105, v105
    s_cmp_eq_u32 s28, 3
    s_cbranch_scc0 AT_nosw
    s_cmp_lt_u32 s3, 4
    s_cbranch_scc0 AT_nosw
    s_setprio 0
    s_lshr_b32 s34, s2, 3
    s_cmp_ge_u32 s34, 16
    s_cselect_b32 s36, s62, s60
    s_cselect_b32 s37, s63, s61
    s_and_b32 s37, s37, 0xffff
    s_mov_b32 s38, 524288
    s_mov_b32 s39, 0x00020000
    s_and_b32 s34, s34, 15
    s_lshl_b32 s34, s34, 15
    s_lshl_b32 s35, s3, 13
    s_add_u32 s34, s34, s35
    s_mov_b32 m0, 134144
    s_nop 0
    buffer_load_dwordx4 v1, s[36:39], s34 offen lds
    s_add_u32 s34, s34, 1024
    buffer_load_dwordx4 v1, s[36:39], s34 offen lds
    s_add_u32 s34, s34, 1024
    buffer_load_dwordx4 v1, s[36:39], s34 offen lds
    s_add_u32 s34, s34, 1024
    buffer_load_dwordx4 v1, s[36:39], s34 offen lds
    s_add_u32 s34, s34, 1024
    buffer_load_dwordx4 v1, s[36:39], s34 offen lds
    s_add_u32 s34, s34, 1024
    buffer_load_dwordx4 v1, s[36:39], s34 offen lds
    s_add_u32 s34, s34, 1024
    buffer_load_dwordx4 v1, s[36:39], s34 offen lds
    s_add_u32 s34, s34, 1024
    buffer_load_dwordx4 v1, s[36:39], s34 offen lds
    s_add_u32 s34, s34, 1024
    s_cmp_lt_u32 s2, 8
    s_cbranch_scc0 AT_nosw
    s_cmp_eq_u32 s3, 0
    s_cbranch_scc0 AT_nosw
    buffer_wbl2 sc1
AT_nosw:
    v_exp_f32 v74, v74
    v_exp_f32 v75, v75
    v_smfmac_f32_32x32x32_bf16 v[58:73], v[122:125], v[98:105], v126
    v_exp_f32 v76, v76
    v_exp_f32 v77, v77
    v_exp_f32 v78, v78
    v_mfma_f32_32x32x16_bf16 v[90:105], v[106:109], v[6:9], v[26:41]
    ds_read_b128 v[106:109], v127 offset:13312
    ds_read_b128 v[114:117], v128 offset:13520
    ds_read_b128 v[122:125], v129 offset:13520
    v_exp_f32 v79, v79
    v_exp_f32 v80, v80
    v_exp_f32 v81, v81
    v_exp_f32 v82, v82
    v_exp_f32 v83, v83
    v_smfmac_f32_32x32x32_bf16 v[42:57], v[110:113], v[74:81], v126
    v_exp_f32 v84, v84
    v_exp_f32 v85, v85
    v_exp_f32 v86, v86
    v_exp_f32 v87, v87
    v_exp_f32 v88, v88
    v_exp_f32 v89, v89
    v_exp_f32 v90, v90
    v_exp_f32 v91, v91
    v_smfmac_f32_32x32x32_bf16 v[42:57], v[118:121], v[82:89], v126
    v_exp_f32 v92, v92
    v_exp_f32 v93, v93
    v_exp_f32 v94, v94
    s_waitcnt lgkmcnt(0)
    v_mfma_f32_32x32x16_bf16 v[74:89], v[106:109], v[2:5], v[10:25]
    v_exp_f32 v95, v95
    v_exp_f32 v96, v96
    v_exp_f32 v97, v97
    v_exp_f32 v98, v98
    v_exp_f32 v99, v99
    v_smfmac_f32_32x32x32_bf16 v[58:73], v[110:113], v[90:97], v126
    v_exp_f32 v100, v100
    v_exp_f32 v101, v101
    v_exp_f32 v102, v102
    v_exp_f32 v103, v103
    v_exp_f32 v104, v104
    v_exp_f32 v105, v105
    v_exp_f32 v74, v74
    v_exp_f32 v75, v75
    v_smfmac_f32_32x32x32_bf16 v[58:73], v[118:121], v[98:105], v126
    v_exp_f32 v76, v76
    v_exp_f32 v77, v77
    v_exp_f32 v78, v78
    v_mfma_f32_32x32x16_bf16 v[90:105], v[106:109], v[6:9], v[26:41]
    ds_read_b128 v[106:109], v127 offset:14336
    ds_read_b128 v[110:113], v128 offset:14560
    ds_read_b128 v[118:121], v129 offset:14560
    v_exp_f32 v79, v79
    v_exp_f32 v80, v80
    v_exp_f32 v81, v81
    v_exp_f32 v82, v82
    v_exp_f32 v83, v83
    v_smfmac_f32_32x32x32_bf16 v[42:57], v[114:117], v[74:81], v126
    v_exp_f32 v84, v84
    v_exp_f32 v85, v85
    v_exp_f32 v86, v86
    v_exp_f32 v87, v87
    v_exp_f32 v88, v88
    v_exp_f32 v89, v89
    v_exp_f32 v90, v90
    v_exp_f32 v91, v91
    v_smfmac_f32_32x32x32_bf16 v[42:57], v[122:125], v[82:89], v126
    v_exp_f32 v92, v92
    v_exp_f32 v93, v93
    v_exp_f32 v94, v94
    s_waitcnt lgkmcnt(0)
    v_mfma_f32_32x32x16_bf16 v[74:89], v[106:109], v[2:5], v[10:25]
    v_exp_f32 v95, v95
    v_exp_f32 v96, v96
    v_exp_f32 v97, v97
    v_exp_f32 v98, v98
    v_exp_f32 v99, v99
    v_smfmac_f32_32x32x32_bf16 v[58:73], v[114:117], v[90:97], v126
    v_exp_f32 v100, v100
    v_exp_f32 v101, v101
    v_exp_f32 v102, v102
    v_exp_f32 v103, v103
    v_exp_f32 v104, v104
    v_exp_f32 v105, v105
    v_exp_f32 v74, v74
    v_exp_f32 v75, v75
    v_smfmac_f32_32x32x32_bf16 v[58:73], v[122:125], v[98:105], v126
    v_exp_f32 v76, v76
    v_exp_f32 v77, v77
    v_exp_f32 v78, v78
    v_mfma_f32_32x32x16_bf16 v[90:105], v[106:109], v[6:9], v[26:41]
    ds_read_b128 v[106:109], v127 offset:15360
    ds_read_b128 v[114:117], v128 offset:15600
    ds_read_b128 v[122:125], v129 offset:15600
    v_exp_f32 v79, v79
    v_exp_f32 v80, v80
    v_exp_f32 v81, v81
    v_exp_f32 v82, v82
    v_exp_f32 v83, v83
    v_smfmac_f32_32x32x32_bf16 v[42:57], v[110:113], v[74:81], v126
    v_exp_f32 v84, v84
    v_exp_f32 v85, v85
    v_exp_f32 v86, v86
    v_exp_f32 v87, v87
    v_exp_f32 v88, v88
    v_exp_f32 v89, v89
    v_exp_f32 v90, v90
    v_exp_f32 v91, v91
    v_smfmac_f32_32x32x32_bf16 v[42:57], v[118:121], v[82:89], v126
    v_exp_f32 v92, v92
    v_exp_f32 v93, v93
    v_exp_f32 v94, v94
    s_waitcnt lgkmcnt(0)
    v_mfma_f32_32x32x16_bf16 v[74:89], v[106:109], v[2:5], v[10:25]
    v_exp_f32 v95, v95
    v_exp_f32 v96, v96
    v_exp_f32 v97, v97
    v_exp_f32 v98, v98
    v_exp_f32 v99, v99
    v_smfmac_f32_32x32x32_bf16 v[58:73], v[110:113], v[90:97], v126
    v_exp_f32 v100, v100
    v_exp_f32 v101, v101
    v_exp_f32 v102, v102
    v_exp_f32 v103, v103
    v_exp_f32 v104, v104
    v_exp_f32 v105, v105
    v_exp_f32 v74, v74
    v_exp_f32 v75, v75
    v_smfmac_f32_32x32x32_bf16 v[58:73], v[118:121], v[98:105], v126
    v_exp_f32 v76, v76
    v_exp_f32 v77, v77
    v_exp_f32 v78, v78
    v_mfma_f32_32x32x16_bf16 v[90:105], v[106:109], v[6:9], v[26:41]
    ds_read_b128 v[106:109], v127 offset:16384
    ds_read_b128 v[110:113], v128 offset:16640
    ds_read_b128 v[118:121], v129 offset:16640
    v_exp_f32 v79, v79
    v_exp_f32 v80, v80
    v_exp_f32 v81, v81
    v_exp_f32 v82, v82
    v_exp_f32 v83, v83
    v_smfmac_f32_32x32x32_bf16 v[42:57], v[114:117], v[74:81], v126
    v_exp_f32 v84, v84
    v_exp_f32 v85, v85
    v_exp_f32 v86, v86
    v_exp_f32 v87, v87
    v_exp_f32 v88, v88
    v_exp_f32 v89, v89
    v_exp_f32 v90, v90
    v_exp_f32 v91, v91
    v_smfmac_f32_32x32x32_bf16 v[42:57], v[122:125], v[82:89], v126
    v_exp_f32 v92, v92
    v_exp_f32 v93, v93
    v_exp_f32 v94, v94
    s_waitcnt lgkmcnt(0)
    v_mfma_f32_32x32x16_bf16 v[74:89], v[106:109], v[2:5], v[10:25]
    v_exp_f32 v95, v95
    v_exp_f32 v96, v96
    v_exp_f32 v97, v97
    v_exp_f32 v98, v98
    v_exp_f32 v99, v99
    v_smfmac_f32_32x32x32_bf16 v[58:73], v[114:117], v[90:97], v126
    v_exp_f32 v100, v100
    v_exp_f32 v101, v101
    v_exp_f32 v102, v102
    v_exp_f32 v103, v103
    v_exp_f32 v104, v104
    v_exp_f32 v105, v105
    v_add_u32 v127, 16384, v127
    v_add_u32 v128, 16640, v128
    v_add_u32 v129, 16640, v129
    s_add_u32 s28, s28, 1
    s_cmp_lt_u32 s28, 4
    s_cbranch_scc1 AT_loop
AT_done:
    s_setprio 0
    s_waitcnt lgkmcnt(0)
    s_nop 1
    v_smfmac_f32_32x32x32_bf16 v[58:73], v[122:125], v[98:105], v126
    v_subrev_u32 v127, 65536, v127
    v_subrev_u32 v128, 66560, v128
    v_subrev_u32 v129, 66560, v129
    s_nop 7
    s_nop 3
    v_mov_b32 v52, v50
    v_mov_b32 v53, v50
    v_mov_b32 v68, v66
    v_mov_b32 v69, v66
    s_nop 1
    v_permlane32_swap_b32 v52, v53
    v_permlane32_swap_b32 v68, v69
    s_cmp_lg_u32 s29, 0
    s_cbranch_scc1 AT_store
    s_mov_b32 s30, 0x71800000
    s_mov_b32 s31, 0x08800000
    v_add_f32 v130, abs(v42), abs(v43)
    v_add_f32 v131, abs(v44), abs(v45)
    v_add_f32 v132, abs(v58), abs(v59)
    v_add_f32 v133, abs(v60), abs(v61)
    v_add_f32 v130, abs(v46), v130
    v_add_f32 v131, abs(v47), v131
    v_add_f32 v132, abs(v62), v132
    v_add_f32 v133, abs(v63), v133
    v_add_f32 v130, abs(v48), v130
    v_add_f32 v131, abs(v49), v131
    v_add_f32 v132, abs(v64), v132
    v_add_f32 v133, abs(v65), v133
    v_add_f32 v130, v130, v131
    v_add_f32 v132, v132, v133
    v_cmp_gt_f32 vcc, s30, v130
    v_cmp_lt_f32 s[16:17], s31, v130
    v_cmp_gt_f32 s[18:19], s30, v132
    v_cmp_lt_f32 s[34:35], s31, v132
    v_cmp_gt_f32 s[36:37], s30, v52
    v_cmp_gt_f32 s[38:39], s30, v68
    s_and_b64 s[16:17], s[16:17], vcc
    s_and_b64 s[16:17], s[16:17], s[18:19]
    s_and_b64 s[16:17], s[16:17], s[34:35]
    s_and_b64 s[16:17], s[16:17], s[36:37]
    s_and_b64 s[16:17], s[16:17], s[38:39]
    s_cmp_eq_u64 s[16:17], -1
    s_cbranch_scc1 AT_store
    s_mov_b32 s29, 1
    v_mov_b32 v10, 0xff800000
    v_mov_b32 v26, 0xff800000
    s_mov_b32 s28, 0
AT_fb_loop:
    ds_read_b128 v[106:109], v127
    s_waitcnt lgkmcnt(0)
    v_mfma_f32_32x32x16_bf16 v[74:89], v[106:109], v[2:5], 0
    v_mfma_f32_32x32x16_bf16 v[90:105], v[106:109], v[6:9], 0
    s_nop 7
    s_nop 7
    v_max3_f32 v10, v10, v74, v75
    v_max3_f32 v10, v10, v76, v77
    v_max3_f32 v10, v10, v78, v79
    v_max3_f32 v10, v10, v80, v81
    v_max3_f32 v10, v10, v82, v83
    v_max3_f32 v10, v10, v84, v85
    v_max3_f32 v10, v10, v86, v87
    v_max3_f32 v10, v10, v88, v89
    v_max3_f32 v26, v26, v90, v91
    v_max3_f32 v26, v26, v92, v93
    v_max3_f32 v26, v26, v94, v95
    v_max3_f32 v26, v26, v96, v97
    v_max3_f32 v26, v26, v98, v99
    v_max3_f32 v26, v26, v100, v101
    v_max3_f32 v26, v26, v102, v103
    v_max3_f32 v26, v26, v104, v105
    v_add_u32 v127, 1024, v127
    s_add_u32 s28, s28, 1
    s_cmp_lt_u32 s28, 64
    s_cbranch_scc1 AT_fb_loop
    v_subrev_u32 v127, 65536, v127
    v_mov_b32 v131, v10
    v_mov_b32 v130, v10
    s_nop 1
    v_permlane32_swap_b32 v130, v131
    s_nop 1
    v_max_f32 v130, v130, v131
    v_sub_f32 v10, 0, v130
    v_mov_b32 v11, v10
    v_mov_b32 v12, v10
    v_mov_b32 v13, v10
    v_mov_b32 v14, v10
    v_mov_b32 v15, v10
    v_mov_b32 v16, v10
    v_mov_b32 v17, v10
    v_mov_b32 v18, v10
    v_mov_b32 v19, v10
    v_mov_b32 v20, v10
    v_mov_b32 v21, v10
    v_mov_b32 v22, v10
    v_mov_b32 v23, v10
    v_mov_b32 v24, v10
    v_mov_b32 v25, v10
    v_mov_b32 v131, v26
    v_mov_b32 v130, v26
    s_nop 1
    v_permlane32_swap_b32 v130, v131
    s_nop 1
    v_max_f32 v130, v130, v131
    v_sub_f32 v26, 0, v130
    v_mov_b32 v27, v26
    v_mov_b32 v28, v26
    v_mov_b32 v29, v26
    v_mov_b32 v30, v26
    v_mov_b32 v31, v26
    v_mov_b32 v32, v26
    v_mov_b32 v33, v26
    v_mov_b32 v34, v26
    v_mov_b32 v35, v26
    v_mov_b32 v36, v26
    v_mov_b32 v37, v26
    v_mov_b32 v38, v26
    v_mov_b32 v39, v26
    v_mov_b32 v40, v26
    v_mov_b32 v41, v26
    v_mov_b32 v42, 0
    v_mov_b32 v43, 0
    v_mov_b32 v44, 0
    v_mov_b32 v45, 0
    v_mov_b32 v46, 0
    v_mov_b32 v47, 0
    v_mov_b32 v48, 0
    v_mov_b32 v49, 0
    v_mov_b32 v50, 0
    v_mov_b32 v51, 0
    v_mov_b32 v52, 0
    v_mov_b32 v53, 0
    v_mov_b32 v54, 0
    v_mov_b32 v55, 0
    v_mov_b32 v56, 0
    v_mov_b32 v57, 0
    v_mov_b32 v58, 0
    v_mov_b32 v59, 0
    v_mov_b32 v60, 0
    v_mov_b32 v61, 0
    v_mov_b32 v62, 0
    v_mov_b32 v63, 0
    v_mov_b32 v64, 0
    v_mov_b32 v65, 0
    v_mov_b32 v66, 0
    v_mov_b32 v67, 0
    v_mov_b32 v68, 0
    v_mov_b32 v69, 0
    v_mov_b32 v70, 0
    v_mov_b32 v71, 0
    v_mov_b32 v72, 0
    v_mov_b32 v73, 0
    s_branch AT_run
AT_store:
    v_rcp_f32 v130, v52
    s_nop 0
    v_mul_f32 v42, v42, v130
    v_mul_f32 v43, v43, v130
    v_mul_f32 v44, v44, v130
    v_mul_f32 v45, v45, v130
    v_mul_f32 v46, v46, v130
    v_mul_f32 v47, v47, v130
    v_mul_f32 v48, v48, v130
    v_mul_f32 v49, v49, v130
    v_cvt_pk_bf16_f32 v74, v42, v43
    v_cvt_pk_bf16_f32 v75, v44, v45
    v_cvt_pk_bf16_f32 v76, v46, v47
    v_cvt_pk_bf16_f32 v77, v48, v49
    buffer_store_dwordx4 v[74:77], v1, s[8:11], s32 offen sc1
    v_rcp_f32 v130, v68
    s_nop 0
    v_mul_f32 v58, v58, v130
    v_mul_f32 v59, v59, v130
    v_mul_f32 v60, v60, v130
    v_mul_f32 v61, v61, v130
    v_mul_f32 v62, v62, v130
    v_mul_f32 v63, v63, v130
    v_mul_f32 v64, v64, v130
    v_mul_f32 v65, v65, v130
    v_cvt_pk_bf16_f32 v78, v58, v59
    v_cvt_pk_bf16_f32 v79, v60, v61
    v_cvt_pk_bf16_f32 v80, v62, v63
    v_cvt_pk_bf16_f32 v81, v64, v65
    s_add_u32 s32, s32, 1024
    buffer_store_dwordx4 v[78:81], v1, s[8:11], s32 offen sc1
    s_mov_b32 s40, s20
    s_mov_b32 s41, s21
    v_mbcnt_lo_u32_b32 v1, -1, 0
    v_mbcnt_hi_u32_b32 v1, -1, v1
    s_and_b32 s44, s2, 7
    s_lshr_b32 s45, s2, 3
    s_lshl_b32 s42, s44, 2
    s_and_b32 s46, s45, 3
    s_add_u32 s42, s42, s46
    s_lshr_b32 s43, s45, 2
    v_lshlrev_b32 v2, 4, v1
    v_lshrrev_b32 v6, 5, v1
    v_lshlrev_b32 v6, 2, v6
    v_bfe_u32 v7, v1, 2, 2
    v_add_u32 v6, v6, v7
    v_lshlrev_b32 v6, 10, v6
    v_bfe_u32 v7, v1, 4, 1
    v_lshl_add_u32 v6, v7, 6, v6
    v_and_b32 v7, 3, v1
    v_lshl_add_u32 v3, v7, 4, v6
    s_mov_b32 s16, s60
    s_and_b32 s17, s61, 0xffff
    s_mov_b32 s18, 0x80000
    s_mov_b32 s19, 0x00020000
    s_mov_b32 s20, s62
    s_and_b32 s21, s63, 0xffff
    s_mov_b32 s22, 0x80000
    s_mov_b32 s23, 0x00020000
    s_mov_b32 s24, s64
    s_and_b32 s25, s65, 0xffff
    s_mov_b32 s26, 0x200000
    s_mov_b32 s27, 0x00020000
    s_lshl_b32 s48, s3, 14
    s_lshl_b32 s44, s43, 7
    s_add_u32 s48, s48, s44
    s_lshl_b32 s49, s3, 11
    s_waitcnt vmcnt(0)
    s_barrier
    s_cmp_lg_u32 s3, 0
    s_cbranch_scc1 OP_noflag
    s_lshl_b32 s44, s41, 2
    s_lshr_b32 s45, s40, 4
    s_add_u32 s44, s44, s45
    s_lshl_b32 s44, s44, 7
    s_and_b32 s45, s40, 15
    s_lshl_b32 s45, s45, 2
    s_add_u32 s44, s44, s45
    s_add_u32 s44, s44, 13635584
    v_mov_b32 v6, s44
    v_mov_b32 v7, s12
    s_mov_b64 exec, 1
    buffer_store_dword v7, v6, s[8:11], 0 offen sc1
    s_mov_b64 exec, -1
    s_lshr_b32 s44, s42, 3
    s_lshl_b32 s44, s44, 9
    s_add_u32 s44, s44, 13635584
    v_bfe_u32 v6, v1, 3, 2
    v_lshlrev_b32 v7, 7, v6
    v_add_u32 v7, s44, v7
    v_and_b32 v6, 7, v1
    v_lshl_add_u32 v11, v6, 3, v7
OP_noflag:
    s_add_u32 s44, s49, 0
    s_mov_b32 m0, s44
    s_add_u32 s45, s48, 0
    buffer_load_dwordx4 v3, s[16:19], s45 offen lds
    s_add_u32 s44, s44, 1024
    s_mov_b32 m0, s44
    s_add_u32 s45, s45, 8192
    buffer_load_dwordx4 v3, s[16:19], s45 offen lds
    s_add_u32 s44, s49, 16384
    s_mov_b32 m0, s44
    s_add_u32 s45, s48, 131072
    buffer_load_dwordx4 v3, s[16:19], s45 offen lds
    s_add_u32 s44, s44, 1024
    s_mov_b32 m0, s44
    s_add_u32 s45, s45, 8192
    buffer_load_dwordx4 v3, s[16:19], s45 offen lds
    s_add_u32 s44, s49, 32768
    s_mov_b32 m0, s44
    s_add_u32 s45, s48, 262144
    buffer_load_dwordx4 v3, s[16:19], s45 offen lds
    s_add_u32 s44, s44, 1024
    s_mov_b32 m0, s44
    s_add_u32 s45, s45, 8192
    buffer_load_dwordx4 v3, s[16:19], s45 offen lds
    s_add_u32 s44, s49, 49152
    s_mov_b32 m0, s44
    s_add_u32 s45, s48, 393216
    buffer_load_dwordx4 v3, s[16:19], s45 offen lds
    s_add_u32 s44, s44, 1024
    s_mov_b32 m0, s44
    s_add_u32 s45, s45, 8192
    buffer_load_dwordx4 v3, s[16:19], s45 offen lds
    s_add_u32 s44, s49, 65536
    s_mov_b32 m0, s44
    s_add_u32 s45, s48, 0
    buffer_load_dwordx4 v3, s[20:23], s45 offen lds
    s_add_u32 s44, s44, 1024
    s_mov_b32 m0, s44
    s_add_u32 s45, s45, 8192
    buffer_load_dwordx4 v3, s[20:23], s45 offen lds
    s_add_u32 s44, s49, 81920
    s_mov_b32 m0, s44
    s_add_u32 s45, s48, 131072
    buffer_load_dwordx4 v3, s[20:23], s45 offen lds
    s_add_u32 s44, s44, 1024
    s_mov_b32 m0, s44
    s_add_u32 s45, s45, 8192
    buffer_load_dwordx4 v3, s[20:23], s45 offen lds
    s_add_u32 s44, s49, 98304
    s_mov_b32 m0, s44
    s_add_u32 s45, s48, 262144
    buffer_load_dwordx4 v3, s[20:23], s45 offen lds
    s_add_u32 s44, s44, 1024
    s_mov_b32 m0, s44
    s_add_u32 s45, s45, 8192
    buffer_load_dwordx4 v3, s[20:23], s45 offen lds
    s_add_u32 s44, s49, 114688
    s_mov_b32 m0, s44
    s_add_u32 s45, s48, 393216
    buffer_load_dwordx4 v3, s[20:23], s45 offen lds
    s_add_u32 s44, s44, 1024
    s_mov_b32 m0, s44
    s_add_u32 s45, s45, 8192
    buffer_load_dwordx4 v3, s[20:23], s45 offen lds
    v_lshrrev_b32 v6, 5, v1
    v_lshlrev_b32 v6, 9, v6
    v_bfe_u32 v7, v1, 2, 2
    v_lshl_add_u32 v6, v7, 6, v6
    v_bfe_u32 v7, v1, 4, 1
    v_lshl_add_u32 v6, v7, 5, v6
    v_and_b32 v7, 3, v1
    v_lshl_add_u32 v6, v7, 3, v6
    s_lshr_b32 s44, s3, 2
    s_lshl_b32 s44, s44, 16
    s_bfe_u32 s45, s3, 0x10001
    s_lshl_b32 s45, s45, 8
    s_add_u32 s44, s44, s45
    v_add_u32 v6, s44, v6
    s_lshr_b32 s44, s3, 2
    s_lshl_b32 s44, s44, 16
    s_and_b32 s45, s3, 1
    s_lshl_b32 s45, s45, 10
    s_add_u32 s44, s44, s45
    v_add_u32 v4, s44, v2
    s_waitcnt vmcnt(0)
    s_barrier
    s_cmp_lg_u32 s3, 0
    s_cbranch_scc1 OP_nop1
    buffer_load_dwordx2 v[20:21], v11, s[8:11], 0 offen sc1
OP_nop1:
    ds_read_b64_tr_b16 v[64:65], v6 offset:0
    ds_read_b64_tr_b16 v[66:67], v6 offset:1024
    ds_read_b64_tr_b16 v[68:69], v6 offset:2048
    ds_read_b64_tr_b16 v[70:71], v6 offset:3072
    ds_read_b64_tr_b16 v[72:73], v6 offset:4096
    ds_read_b64_tr_b16 v[74:75], v6 offset:5120
    ds_read_b64_tr_b16 v[76:77], v6 offset:6144
    ds_read_b64_tr_b16 v[78:79], v6 offset:7168
    ds_read_b64_tr_b16 v[80:81], v6 offset:8192
    ds_read_b64_tr_b16 v[82:83], v6 offset:9216
    s_waitcnt lgkmcnt(4)
    ds_read_b64_tr_b16 v[84:85], v6 offset:10240
    ds_read_b64_tr_b16 v[86:87], v6 offset:11264
    ds_read_b64_tr_b16 v[88:89], v6 offset:12288
    ds_read_b64_tr_b16 v[90:91], v6 offset:13312
    ds_read_b64_tr_b16 v[92:93], v6 offset:14336
    ds_read_b64_tr_b16 v[94:95], v6 offset:15360
    ds_read_b64_tr_b16 v[96:97], v6 offset:16384
    ds_read_b64_tr_b16 v[98:99], v6 offset:17408
    ds_read_b64_tr_b16 v[100:101], v6 offset:18432
    ds_read_b64_tr_b16 v[102:103], v6 offset:19456
    s_waitcnt lgkmcnt(4)
    ds_read_b64_tr_b16 v[104:105], v6 offset:20480
    ds_read_b64_tr_b16 v[106:107], v6 offset:21504
    ds_read_b64_tr_b16 v[108:109], v6 offset:22528
    ds_read_b64_tr_b16 v[110:111], v6 offset:23552
    ds_read_b64_tr_b16 v[112:113], v6 offset:24576
    ds_read_b64_tr_b16 v[114:115], v6 offset:25600
    ds_read_b64_tr_b16 v[116:117], v6 offset:26624
    ds_read_b64_tr_b16 v[118:119], v6 offset:27648
    ds_read_b64_tr_b16 v[120:121], v6 offset:28672
    ds_read_b64_tr_b16 v[122:123], v6 offset:29696
    s_waitcnt lgkmcnt(4)
    ds_read_b64_tr_b16 v[124:125], v6 offset:30720
    ds_read_b64_tr_b16 v[126:127], v6 offset:31744
    ds_read_b64_tr_b16 v[128:129], v6 offset:32768
    ds_read_b64_tr_b16 v[130:131], v6 offset:33792
    ds_read_b64_tr_b16 v[132:133], v6 offset:34816
    ds_read_b64_tr_b16 v[134:135], v6 offset:35840
    ds_read_b64_tr_b16 v[136:137], v6 offset:36864
    ds_read_b64_tr_b16 v[138:139], v6 offset:37888
    ds_read_b64_tr_b16 v[140:141], v6 offset:38912
    ds_read_b64_tr_b16 v[142:143], v6 offset:39936
    s_waitcnt lgkmcnt(4)
    ds_read_b64_tr_b16 v[144:145], v6 offset:40960
    ds_read_b64_tr_b16 v[146:147], v6 offset:41984
    ds_read_b64_tr_b16 v[148:149], v6 offset:43008
    ds_read_b64_tr_b16 v[150:151], v6 offset:44032
    ds_read_b64_tr_b16 v[152:153], v6 offset:45056
    ds_read_b64_tr_b16 v[154:155], v6 offset:46080
    ds_read_b64_tr_b16 v[156:157], v6 offset:47104
    ds_read_b64_tr_b16 v[158:159], v6 offset:48128
    ds_read_b64_tr_b16 v[160:161], v6 offset:49152
    ds_read_b64_tr_b16 v[162:163], v6 offset:50176
    s_waitcnt lgkmcnt(4)
    ds_read_b64_tr_b16 v[164:165], v6 offset:51200
    ds_read_b64_tr_b16 v[166:167], v6 offset:52224
    ds_read_b64_tr_b16 v[168:169], v6 offset:53248
    ds_read_b64_tr_b16 v[170:171], v6 offset:54272
    ds_read_b64_tr_b16 v[172:173], v6 offset:55296
    ds_read_b64_tr_b16 v[174:175], v6 offset:56320
    ds_read_b64_tr_b16 v[176:177], v6 offset:57344
    ds_read_b64_tr_b16 v[178:179], v6 offset:58368
    ds_read_b64_tr_b16 v[180:181], v6 offset:59392
    ds_read_b64_tr_b16 v[182:183], v6 offset:60416
    s_waitcnt lgkmcnt(4)
    ds_read_b64_tr_b16 v[184:185], v6 offset:61440
    ds_read_b64_tr_b16 v[186:187], v6 offset:62464
    ds_read_b64_tr_b16 v[188:189], v6 offset:63488
    ds_read_b64_tr_b16 v[190:191], v6 offset:64512
    v_mov_b32 v24, 0
    v_mov_b32 v25, 0
    v_mov_b32 v26, 0
    v_mov_b32 v27, 0
    v_mov_b32 v28, 0
    v_mov_b32 v29, 0
    v_mov_b32 v30, 0
    v_mov_b32 v31, 0
    v_mov_b32 v32, 0
    v_mov_b32 v33, 0
    v_mov_b32 v34, 0
    v_mov_b32 v35, 0
    v_mov_b32 v36, 0
    v_mov_b32 v37, 0
    v_mov_b32 v38, 0
    v_mov_b32 v39, 0
    s_cmp_lg_u32 s3, 0
    s_cbranch_scc1 OP_polled
    s_waitcnt vmcnt(0)
    v_cmp_eq_u32 vcc, s12, v20
    v_cmp_eq_u32 s[52:53], s12, v21
    s_nop 1
    s_and_b64 vcc, vcc, s[52:53]
    s_nop 1
    s_cmp_eq_u64 vcc, -1
    s_cbranch_scc1 OP_seen
    s_mov_b32 s14, 131072
OP_poll:
    buffer_load_dwordx2 v[8:9], v11, s[8:11], 0 offen sc1
    s_waitcnt vmcnt(0)
    v_cmp_eq_u32 vcc, s12, v8
    v_cmp_eq_u32 s[52:53], s12, v9
    s_nop 1
    s_and_b64 vcc, vcc, s[52:53]
    s_nop 1
    s_cmp_eq_u64 vcc, -1
    s_cbranch_scc1 OP_poll_ok
    s_sleep 2
    s_sub_u32 s14, s14, 1
    s_cmp_lg_u32 s14, 0
    s_cbranch_scc1 OP_poll
OP_poll_ok:
OP_seen:
    s_cmp_lg_u32 s2, 0
    s_cbranch_scc1 OP_polled
    v_mov_b32 v6, 13639680
    v_mov_b32 v7, s12
    s_mov_b64 exec, 1
    buffer_store_dword v7, v6, s[8:11], 0 offen sc1
    s_mov_b64 exec, -1
    s_waitcnt vmcnt(0)
OP_polled:
    v_and_b32 v6, 31, v1
    v_lshlrev_b32 v6, 2, v6
    s_lshl_b32 s46, s42, 8
    s_and_b32 s45, s3, 1
    s_lshl_b32 s45, s45, 7
    s_add_u32 s46, s46, s45
    s_add_u32 s46, s46, 13664256
    s_lshl_b32 s47, s3, 16
    s_lshl_b32 s44, s42, 11
    s_add_u32 s47, s47, s44
    s_add_u32 s47, s47, 9437184
    s_waitcnt lgkmcnt(0)
    s_barrier
    s_add_u32 s44, s49, 0
    s_mov_b32 m0, s44
    s_add_u32 s45, s47, 0
    buffer_load_dwordx4 v2, s[8:11], s45 offen sc1 lds
    s_add_u32 s44, s49, 1024
    s_mov_b32 m0, s44
    s_add_u32 s45, s47, 1024
    buffer_load_dwordx4 v2, s[8:11], s45 offen sc1 lds
    s_add_u32 s44, s49, 65536
    s_mov_b32 m0, s44
    s_add_u32 s45, s47, 2097152
    buffer_load_dwordx4 v2, s[8:11], s45 offen sc1 lds
    s_add_u32 s44, s49, 66560
    s_mov_b32 m0, s44
    s_add_u32 s45, s47, 2098176
    buffer_load_dwordx4 v2, s[8:11], s45 offen sc1 lds
    buffer_load_dword v10, v6, s[8:11], s46 offen sc1
    s_add_u32 s44, s49, 16384
    s_mov_b32 m0, s44
    s_add_u32 s45, s47, 524288
    buffer_load_dwordx4 v2, s[8:11], s45 offen sc1 lds
    s_add_u32 s44, s49, 17408
    s_mov_b32 m0, s44
    s_add_u32 s45, s47, 525312
    buffer_load_dwordx4 v2, s[8:11], s45 offen sc1 lds
    s_add_u32 s44, s49, 81920
    s_mov_b32 m0, s44
    s_add_u32 s45, s47, 2621440
    buffer_load_dwordx4 v2, s[8:11], s45 offen sc1 lds
    s_add_u32 s44, s49, 82944
    s_mov_b32 m0, s44
    s_add_u32 s45, s47, 2622464
    buffer_load_dwordx4 v2, s[8:11], s45 offen sc1 lds
    s_waitcnt vmcnt(5)
    s_barrier
    s_add_u32 s44, s49, 32768
    s_mov_b32 m0, s44
    s_add_u32 s45, s47, 1048576
    buffer_load_dwordx4 v2, s[8:11], s45 offen sc1 lds
    s_add_u32 s44, s49, 33792
    s_mov_b32 m0, s44
    s_add_u32 s45, s47, 1049600
    buffer_load_dwordx4 v2, s[8:11], s45 offen sc1 lds
    s_add_u32 s44, s49, 98304
    s_mov_b32 m0, s44
    s_add_u32 s45, s47, 3145728
    buffer_load_dwordx4 v2, s[8:11], s45 offen sc1 lds
    s_add_u32 s44, s49, 99328
    s_mov_b32 m0, s44
    s_add_u32 s45, s47, 3146752
    buffer_load_dwordx4 v2, s[8:11], s45 offen sc1 lds
    ds_read_b128 v[12:15], v4 offset:0
    ds_read_b128 v[16:19], v4 offset:2048
    s_waitcnt lgkmcnt(1)
    v_mfma_f32_32x32x16_bf16 v[24:39], v[64:67], v[12:15], v[24:39]
    ds_read_b128 v[12:15], v4 offset:4096
    s_waitcnt lgkmcnt(1)
    v_mfma_f32_32x32x16_bf16 v[24:39], v[68:71], v[16:19], v[24:39]
    ds_read_b128 v[16:19], v4 offset:6144
    s_waitcnt lgkmcnt(1)
    v_mfma_f32_32x32x16_bf16 v[24:39], v[72:75], v[12:15], v[24:39]
    ds_read_b128 v[12:15], v4 offset:8192
    s_waitcnt lgkmcnt(1)
    v_mfma_f32_32x32x16_bf16 v[24:39], v[76:79], v[16:19], v[24:39]
    ds_read_b128 v[16:19], v4 offset:10240
    s_waitcnt lgkmcnt(1)
    v_mfma_f32_32x32x16_bf16 v[24:39], v[80:83], v[12:15], v[24:39]
    ds_read_b128 v[12:15], v4 offset:12288
    s_waitcnt lgkmcnt(1)
    v_mfma_f32_32x32x16_bf16 v[24:39], v[84:87], v[16:19], v[24:39]
    ds_read_b128 v[16:19], v4 offset:14336
    s_waitcnt lgkmcnt(1)
    v_mfma_f32_32x32x16_bf16 v[24:39], v[88:91], v[12:15], v[24:39]
    s_waitcnt lgkmcnt(0)
    v_mfma_f32_32x32x16_bf16 v[24:39], v[92:95], v[16:19], v[24:39]
    s_waitcnt vmcnt(4)
    s_barrier
    s_add_u32 s44, s49, 49152
    s_mov_b32 m0, s44
    s_add_u32 s45, s47, 1572864
    buffer_load_dwordx4 v2, s[8:11], s45 offen sc1 lds
    s_add_u32 s44, s49, 50176
    s_mov_b32 m0, s44
    s_add_u32 s45, s47, 1573888
    buffer_load_dwordx4 v2, s[8:11], s45 offen sc1 lds
    s_add_u32 s44, s49, 114688
    s_mov_b32 m0, s44
    s_add_u32 s45, s47, 3670016
    buffer_load_dwordx4 v2, s[8:11], s45 offen sc1 lds
    s_add_u32 s44, s49, 115712
    s_mov_b32 m0, s44
    s_add_u32 s45, s47, 3671040
    buffer_load_dwordx4 v2, s[8:11], s45 offen sc1 lds
    ds_read_b128 v[12:15], v4 offset:16384
    ds_read_b128 v[16:19], v4 offset:18432
    s_waitcnt lgkmcnt(1)
    v_mfma_f32_32x32x16_bf16 v[24:39], v[96:99], v[12:15], v[24:39]
    ds_read_b128 v[12:15], v4 offset:20480
    s_waitcnt lgkmcnt(1)
    v_mfma_f32_32x32x16_bf16 v[24:39], v[100:103], v[16:19], v[24:39]
    ds_read_b128 v[16:19], v4 offset:22528
    s_waitcnt lgkmcnt(1)
    v_mfma_f32_32x32x16_bf16 v[24:39], v[104:107], v[12:15], v[24:39]
    ds_read_b128 v[12:15], v4 offset:24576
    s_waitcnt lgkmcnt(1)
    v_mfma_f32_32x32x16_bf16 v[24:39], v[108:111], v[16:19], v[24:39]
    ds_read_b128 v[16:19], v4 offset:26624
    s_waitcnt lgkmcnt(1)
    v_mfma_f32_32x32x16_bf16 v[24:39], v[112:115], v[12:15], v[24:39]
    ds_read_b128 v[12:15], v4 offset:28672
    s_waitcnt lgkmcnt(1)
    v_mfma_f32_32x32x16_bf16 v[24:39], v[116:119], v[16:19], v[24:39]
    ds_read_b128 v[16:19], v4 offset:30720
    s_waitcnt lgkmcnt(1)
    v_mfma_f32_32x32x16_bf16 v[24:39], v[120:123], v[12:15], v[24:39]
    s_waitcnt lgkmcnt(0)
    v_mfma_f32_32x32x16_bf16 v[24:39], v[124:127], v[16:19], v[24:39]
    s_waitcnt vmcnt(4)
    s_barrier
    ds_read_b128 v[12:15], v4 offset:32768
    ds_read_b128 v[16:19], v4 offset:34816
    s_waitcnt lgkmcnt(1)
    v_mfma_f32_32x32x16_bf16 v[24:39], v[128:131], v[12:15], v[24:39]
    ds_read_b128 v[12:15], v4 offset:36864
    s_waitcnt lgkmcnt(1)
    v_mfma_f32_32x32x16_bf16 v[24:39], v[132:135], v[16:19], v[24:39]
    ds_read_b128 v[16:19], v4 offset:38912
    s_waitcnt lgkmcnt(1)
    v_mfma_f32_32x32x16_bf16 v[24:39], v[136:139], v[12:15], v[24:39]
    ds_read_b128 v[12:15], v4 offset:40960
    s_waitcnt lgkmcnt(1)
    v_mfma_f32_32x32x16_bf16 v[24:39], v[140:143], v[16:19], v[24:39]
    ds_read_b128 v[16:19], v4 offset:43008
    s_waitcnt lgkmcnt(1)
    v_mfma_f32_32x32x16_bf16 v[24:39], v[144:147], v[12:15], v[24:39]
    ds_read_b128 v[12:15], v4 offset:45056
    s_waitcnt lgkmcnt(1)
    v_mfma_f32_32x32x16_bf16 v[24:39], v[148:151], v[16:19], v[24:39]
    ds_read_b128 v[16:19], v4 offset:47104
    s_waitcnt lgkmcnt(1)
    v_mfma_f32_32x32x16_bf16 v[24:39], v[152:155], v[12:15], v[24:39]
    s_waitcnt lgkmcnt(0)
    v_mfma_f32_32x32x16_bf16 v[24:39], v[156:159], v[16:19], v[24:39]
    s_waitcnt vmcnt(0)
    s_barrier
    ds_read_b128 v[12:15], v4 offset:49152
    ds_read_b128 v[16:19], v4 offset:51200
    s_waitcnt lgkmcnt(1)
    v_mfma_f32_32x32x16_bf16 v[24:39], v[160:163], v[12:15], v[24:39]
    ds_read_b128 v[12:15], v4 offset:53248
    s_waitcnt lgkmcnt(1)
    v_mfma_f32_32x32x16_bf16 v[24:39], v[164:167], v[16:19], v[24:39]
    ds_read_b128 v[16:19], v4 offset:55296
    s_waitcnt lgkmcnt(1)
    v_mfma_f32_32x32x16_bf16 v[24:39], v[168:171], v[12:15], v[24:39]
    ds_read_b128 v[12:15], v4 offset:57344
    s_waitcnt lgkmcnt(1)
    v_mfma_f32_32x32x16_bf16 v[24:39], v[172:175], v[16:19], v[24:39]
    ds_read_b128 v[16:19], v4 offset:59392
    s_waitcnt lgkmcnt(1)
    v_mfma_f32_32x32x16_bf16 v[24:39], v[176:179], v[12:15], v[24:39]
    ds_read_b128 v[12:15], v4 offset:61440
    s_waitcnt lgkmcnt(1)
    v_mfma_f32_32x32x16_bf16 v[24:39], v[180:183], v[16:19], v[24:39]
    ds_read_b128 v[16:19], v4 offset:63488
    s_waitcnt lgkmcnt(1)
    v_mfma_f32_32x32x16_bf16 v[24:39], v[184:187], v[12:15], v[24:39]
    s_waitcnt lgkmcnt(0)
    v_mfma_f32_32x32x16_bf16 v[24:39], v[188:191], v[16:19], v[24:39]
    s_barrier
    v_sub_f32 v8, 1.0, v10
    s_cmp_ge_u32 s3, 4
    s_cselect_b64 vcc, -1, 0
    v_cndmask_b32 v10, v10, v8, vcc
    s_nop 7
    v_mul_f32 v24, v24, v10
    v_mul_f32 v25, v25, v10
    v_mul_f32 v26, v26, v10
    v_mul_f32 v27, v27, v10
    v_mul_f32 v28, v28, v10
    v_mul_f32 v29, v29, v10
    v_mul_f32 v30, v30, v10
    v_mul_f32 v31, v31, v10
    v_mul_f32 v32, v32, v10
    v_mul_f32 v33, v33, v10
    v_mul_f32 v34, v34, v10
    v_mul_f32 v35, v35, v10
    v_mul_f32 v36, v36, v10
    v_mul_f32 v37, v37, v10
    v_mul_f32 v38, v38, v10
    v_mul_f32 v39, v39, v10
    s_and_b32 s44, s3, 3
    s_lshl_b32 s44, s44, 12
    s_lshr_b32 s45, s3, 2
    s_lshl_b32 s46, s45, 11
    s_add_u32 s46, s46, s44
    v_add_u32 v6, s46, v2
    s_xor_b32 s46, s46, 2048
    v_add_u32 v7, s46, v2
    s_cmp_eq_u32 s45, 0
    s_cbranch_scc0 OP_k1
    ds_write_b128 v6, v[32:35]
    ds_write_b128 v6, v[36:39] offset:1024
    s_waitcnt lgkmcnt(0)
    s_barrier
    ds_read_b128 v[40:43], v7
    ds_read_b128 v[44:47], v7 offset:1024
    s_waitcnt lgkmcnt(0)
    v_add_f32 v40, v40, v24
    v_add_f32 v41, v41, v25
    v_add_f32 v42, v42, v26
    v_add_f32 v43, v43, v27
    v_add_f32 v44, v44, v28
    v_add_f32 v45, v45, v29
    v_add_f32 v46, v46, v30
    v_add_f32 v47, v47, v31
    s_branch OP_st
OP_k1:
    ds_write_b128 v6, v[24:27]
    ds_write_b128 v6, v[28:31] offset:1024
    s_waitcnt lgkmcnt(0)
    s_barrier
    ds_read_b128 v[40:43], v7
    ds_read_b128 v[44:47], v7 offset:1024
    s_waitcnt lgkmcnt(0)
    v_add_f32 v40, v40, v32
    v_add_f32 v41, v41, v33
    v_add_f32 v42, v42, v34
    v_add_f32 v43, v43, v35
    v_add_f32 v44, v44, v36
    v_add_f32 v45, v45, v37
    v_add_f32 v46, v46, v38
    v_add_f32 v47, v47, v39
OP_st:
    v_cvt_pk_bf16_f32 v12, v40, v41
    v_cvt_pk_bf16_f32 v13, v42, v43
    v_cvt_pk_bf16_f32 v14, v44, v45
    v_cvt_pk_bf16_f32 v15, v46, v47
    s_nop 1
    v_permlane32_swap_b32 v12, v14
    v_permlane32_swap_b32 v13, v15
    v_and_b32 v6, 31, v1
    v_lshlrev_b32 v6, 10, v6
    v_lshrrev_b32 v7, 5, v1
    v_lshl_add_u32 v6, v7, 4, v6
    s_lshl_b32 s44, s42, 16
    s_and_b32 s45, s3, 1
    s_lshl_b32 s45, s45, 15
    s_add_u32 s44, s44, s45
    s_lshl_b32 s45, s43, 7
    s_add_u32 s44, s44, s45
    s_bfe_u32 s45, s3, 0x10001
    s_lshl_b32 s45, s45, 6
    s_add_u32 s44, s44, s45
    s_lshr_b32 s45, s3, 2
    s_lshl_b32 s45, s45, 5
    s_add_u32 s44, s44, s45
    buffer_store_dwordx4 v[12:15], v6, s[24:27], s44 offen
L_exit:
    s_endpgm
.section .rodata,"a"
.p2align 6
.amdhsa_kernel gated_mix__softmax_full_mha__grouped_kv_mqa__prompt_kernel
  .amdhsa_next_free_vgpr 192
  .amdhsa_next_free_sgpr 102
  .amdhsa_accum_offset 192
  .amdhsa_group_segment_fixed_size 0
  .amdhsa_kernarg_size 96
  .amdhsa_user_sgpr_count 2
  .amdhsa_user_sgpr_kernarg_segment_ptr 1
  .amdhsa_system_sgpr_workgroup_id_x 1
.end_amdhsa_kernel
```
